```python
import torch

def _softmax(x, axis=-1):
    return torch.softmax(x, dim=axis)
def _gelu(x):
    return torch.nn.functional.gelu(x, approximate="tanh")
def _silu(x):
    return torch.nn.functional.silu(x)
def _sigmoid(x):
    return torch.sigmoid(x)
def _layernorm(x, axis=-1, eps=1e-5):
    m = x.mean(dim=axis, keepdim=True)
    v = x.var(dim=axis, keepdim=True, unbiased=False)
    return (x - m) / torch.sqrt(v + eps)
def _scatter_add(tgt, idx, src, axis=0):
    return tgt.clone().index_add_(axis, idx, src)
def _segment_sum(src, seg, n):
    out = torch.zeros((n,) + src.shape[1:], dtype=src.dtype)
    return out.index_add_(0, seg, src)
def _pad(x, pw):
    flat = tuple(v for pair in reversed(pw) for v in pair)
    return torch.nn.functional.pad(x, flat)

kernel_name = 'gated_mix__ssm_conv_s4d__dense_activation_silu__prompt'

def setup_inputs():

    _w = (lambda a: (lambda t: t.to(torch.bfloat16) if t.is_floating_point() else t)(torch.as_tensor(a)))
    def _A_setup():
        Bsz, L, D, N = 1, 2048, 640, 128
        return {
            "u": _w((lambda *s: torch.randn(*s, dtype=torch.bfloat16) * 0.05)(Bsz, L, D)),
            "log_A_real": _w((lambda *s: torch.randn(*s, dtype=torch.bfloat16) * 3.2)(D, N) * 0.5),
            "A_imag": _w((lambda *s: torch.randn(*s, dtype=torch.bfloat16) * 0.05)(D, N) * 3.14),
            "C_real": _w((lambda *s: torch.randn(*s, dtype=torch.bfloat16) * 0.1)(D, N) / N ** 0.5),
            "C_imag": _w((lambda *s: torch.randn(*s, dtype=torch.bfloat16) * 0.1)(D, N) / N ** 0.5),
            "log_dt": _w((lambda *s: torch.randn(*s, dtype=torch.bfloat16) * 0.05)(D) * 0.5 - 4.0),
            "D_skip": _w((lambda *s: torch.randn(*s, dtype=torch.bfloat16) * 0.05)(D)),
        }
    _A_in = _A_setup()

    def _B_setup():
        B, S, D, F = 1, 2048, 640, 1728
        return {
            "x": _w((lambda *s: torch.randn(*s, dtype=torch.bfloat16) * 0.05)(B, S, D)),
            "w1": _w((lambda *s: torch.randn(*s, dtype=torch.bfloat16) * 3.2)(D, F) * (D ** -0.5)),
            "w2": _w((lambda *s: torch.randn(*s, dtype=torch.bfloat16) * 0.1)(F, D) * (F ** -0.5)),
        }
    _B_in = _B_setup()

    return {
        "A_u": _A_in["u"],
        "A_log_A_real": _A_in["log_A_real"],
        "A_A_imag": _A_in["A_imag"],
        "A_C_real": _A_in["C_real"],
        "A_C_imag": _A_in["C_imag"],
        "A_log_dt": _A_in["log_dt"],
        "A_D_skip": _A_in["D_skip"],
        "B_x": _B_in["x"],
        "B_w1": _B_in["w1"],
        "B_w2": _B_in["w2"],
        "gate_w": _w((lambda *s: torch.randn(*s, dtype=torch.bfloat16) * 0.05)(640) * 16.0),
    }

def reference(A_u, A_log_A_real, A_A_imag, A_C_real, A_C_imag, A_log_dt, A_D_skip, B_x, B_w1, B_w2, gate_w):
    def _A_ref(u, log_A_real, A_imag, C_real, C_imag, log_dt, D_skip):
        L = u.shape[1]
        dt = torch.exp(log_dt)
        A = -torch.exp(log_A_real) + 1j * A_imag
        C = (C_real + 1j * C_imag) * dt[:, None]
        pos = (lambda x, dt: x.to(dt))(torch.arange(L), log_dt.dtype)
        P = torch.exp((A * dt[:, None])[:, :, None] * pos[None, None, :])
        K = 2.0 * torch.einsum("dn,dnl->dl", C, P).real
        L2 = 2 * L
        u_t = (lambda x, *d: x.permute(*d))(u, 0, 2, 1)
        Kf = (lambda x, *a, **k: torch.fft.rfft(x.float(), *a, **k))(K, L2)
        Uf = (lambda x, *a, **k: torch.fft.rfft(x.float(), *a, **k))(u_t, L2)
        y = (lambda x, *a, **k: torch.fft.irfft(x, *a, **k).to(torch.bfloat16))(Uf * Kf[None, :, :], L2)[:, :, :L]
        y = (lambda x, *d: x.permute(*d))(y, 0, 2, 1)
        return y + u * D_skip[None, None, :]

    def _B_ref(x, w1, w2):
        h = torch.einsum("bsd,df->bsf", x, w1)
        h = _silu(h)
        out = torch.einsum("bsf,fd->bsd", h, w2)
        return out

    x = A_u
    g = _sigmoid((x * gate_w).sum(-1, keepdims=True))
    a = _A_ref(x, A_log_A_real, A_A_imag, A_C_real, A_C_imag, A_log_dt, A_D_skip)
    b = _B_ref(x, B_w1, B_w2)
    return g * a + (1 - g) * b
```

```asm
; @launch kernel=k1_kernel grid=(688,1,1) block=(512,1,1) lds=73728
; @launch kernel=gemm2_kernel grid=(160,1,1) block=(256,1,1) lds=147456
.amdgcn_target "amdgcn-amd-amdhsa--gfx950"
.text
.globl k1_kernel
.p2align 8
.type k1_kernel,@function
k1_kernel:
    s_cmp_ge_u32 s2, 688
    s_cbranch_scc1 L_end_k1_kernel
    s_cmp_lt_u32 s2, 112
    s_cbranch_scc1 L_k1_g
    s_sub_u32 s2, s2, 112
    s_cmp_lt_u32 s2, 320
    s_cbranch_scc1 L_k1_c
    s_sub_u32 s2, s2, 320
    s_load_dwordx2 s[16:17], s[0:1], 0
    s_load_dwordx2 s[18:19], s[0:1], 80
    s_load_dwordx2 s[20:21], s[0:1], 104
    s_waitcnt lgkmcnt(0)
    s_mov_b32 s4, s16
    s_mov_b32 s5, s17
    s_mov_b32 s6, 0x280000
    s_mov_b32 s7, 0x00020000
    s_mov_b32 s8, s18
    s_mov_b32 s9, s19
    s_mov_b32 s10, 0x500
    s_mov_b32 s11, 0x00020000
    s_mov_b32 s12, s20
    s_mov_b32 s13, s21
    s_mov_b32 s14, 0xc02000
    s_mov_b32 s15, 0x00020000
    v_and_b32 v1, 63, v0
    v_lshrrev_b32 v2, 6, v0
    s_lshl_b32 s22, s2, 3
    v_add_u32 v2, s22, v2
    v_mul_u32_u24 v3, 1280, v2
    v_lshl_add_u32 v3, v1, 2, v3
    v_lshlrev_b32 v4, 2, v1
    buffer_load_dword v8, v3, s[4:7], 0 offen offset:0
    buffer_load_dword v13, v4, s[8:11], 0 offen offset:0
    buffer_load_dword v9, v3, s[4:7], 0 offen offset:256
    buffer_load_dword v14, v4, s[8:11], 0 offen offset:256
    buffer_load_dword v10, v3, s[4:7], 0 offen offset:512
    buffer_load_dword v15, v4, s[8:11], 0 offen offset:512
    buffer_load_dword v11, v3, s[4:7], 0 offen offset:768
    buffer_load_dword v16, v4, s[8:11], 0 offen offset:768
    buffer_load_dword v12, v3, s[4:7], 0 offen offset:1024
    buffer_load_dword v17, v4, s[8:11], 0 offen offset:1024
    v_mov_b32 v18, 0
    s_waitcnt vmcnt(0)
    v_lshlrev_b32 v4, 16, v8
    v_lshlrev_b32 v5, 16, v13
    v_and_b32 v6, 0xffff0000, v8
    v_and_b32 v7, 0xffff0000, v13
    v_mul_f32 v4, v4, v5
    v_mul_f32 v6, v6, v7
    v_cvt_pk_bf16_f32 v4, v4, v6
    v_lshlrev_b32 v5, 16, v4
    v_and_b32 v6, 0xffff0000, v4
    v_add_f32 v18, v18, v5
    v_add_f32 v18, v18, v6
    v_lshlrev_b32 v4, 16, v9
    v_lshlrev_b32 v5, 16, v14
    v_and_b32 v6, 0xffff0000, v9
    v_and_b32 v7, 0xffff0000, v14
    v_mul_f32 v4, v4, v5
    v_mul_f32 v6, v6, v7
    v_cvt_pk_bf16_f32 v4, v4, v6
    v_lshlrev_b32 v5, 16, v4
    v_and_b32 v6, 0xffff0000, v4
    v_add_f32 v18, v18, v5
    v_add_f32 v18, v18, v6
    v_lshlrev_b32 v4, 16, v10
    v_lshlrev_b32 v5, 16, v15
    v_and_b32 v6, 0xffff0000, v10
    v_and_b32 v7, 0xffff0000, v15
    v_mul_f32 v4, v4, v5
    v_mul_f32 v6, v6, v7
    v_cvt_pk_bf16_f32 v4, v4, v6
    v_lshlrev_b32 v5, 16, v4
    v_and_b32 v6, 0xffff0000, v4
    v_add_f32 v18, v18, v5
    v_add_f32 v18, v18, v6
    v_lshlrev_b32 v4, 16, v11
    v_lshlrev_b32 v5, 16, v16
    v_and_b32 v6, 0xffff0000, v11
    v_and_b32 v7, 0xffff0000, v16
    v_mul_f32 v4, v4, v5
    v_mul_f32 v6, v6, v7
    v_cvt_pk_bf16_f32 v4, v4, v6
    v_lshlrev_b32 v5, 16, v4
    v_and_b32 v6, 0xffff0000, v4
    v_add_f32 v18, v18, v5
    v_add_f32 v18, v18, v6
    v_lshlrev_b32 v4, 16, v12
    v_lshlrev_b32 v5, 16, v17
    v_and_b32 v6, 0xffff0000, v12
    v_and_b32 v7, 0xffff0000, v17
    v_mul_f32 v4, v4, v5
    v_mul_f32 v6, v6, v7
    v_cvt_pk_bf16_f32 v4, v4, v6
    v_lshlrev_b32 v5, 16, v4
    v_and_b32 v6, 0xffff0000, v4
    v_add_f32 v18, v18, v5
    v_add_f32 v18, v18, v6
    ds_swizzle_b32 v4, v18 offset:0x41f
    s_waitcnt lgkmcnt(0)
    v_add_f32 v18, v18, v4
    ds_swizzle_b32 v4, v18 offset:0x81f
    s_waitcnt lgkmcnt(0)
    v_add_f32 v18, v18, v4
    ds_swizzle_b32 v4, v18 offset:0x101f
    s_waitcnt lgkmcnt(0)
    v_add_f32 v18, v18, v4
    ds_swizzle_b32 v4, v18 offset:0x201f
    s_waitcnt lgkmcnt(0)
    v_add_f32 v18, v18, v4
    ds_swizzle_b32 v4, v18 offset:0x401f
    s_waitcnt lgkmcnt(0)
    v_add_f32 v18, v18, v4
    s_nop 1
    v_readlane_b32 s23, v18, 0
    v_readlane_b32 s24, v18, 32
    s_nop 3
    v_mov_b32 v4, s23
    v_add_f32 v4, s24, v4
    v_cvt_pk_bf16_f32 v4, v4, v4
    v_lshlrev_b32 v4, 16, v4
    v_mul_f32 v4, 0xbfb8aa3b, v4
    v_exp_f32 v4, v4
    s_nop 0
    v_add_f32 v4, 1.0, v4
    v_rcp_f32 v4, v4
    s_nop 0
    v_cvt_pk_bf16_f32 v4, v4, v4
    v_lshlrev_b32 v4, 16, v4
    v_lshlrev_b32 v2, 2, v2
    v_cmp_eq_u32 vcc, 0, v1
    s_and_saveexec_b64 s[26:27], vcc
    s_mov_b32 s23, 0xc00000
    buffer_store_dword v4, v2, s[12:15], s23 offen
    s_mov_b64 exec, s[26:27]
    s_load_dwordx2 s[28:29], s[0:1], 72
    s_waitcnt lgkmcnt(0)
    s_mov_b32 s32, s28
    s_mov_b32 s33, s29
    s_mov_b32 s34, 0x21c000
    s_mov_b32 s35, 0x00020000
    s_mul_i32 s23, s2, 8640
    v_lshlrev_b32 v4, 4, v0
    buffer_load_dwordx4 v[20:23], v4, s[32:35], s23 offen
    v_cmp_gt_u32 vcc, 28, v0
    s_and_saveexec_b64 s[26:27], vcc
    buffer_load_dwordx4 v[24:27], v4, s[32:35], s23 offen offset:8192
    s_mov_b64 exec, s[26:27]
    s_waitcnt vmcnt(0)
    s_endpgm
L_k1_c:
    s_and_b32 s3, s2, 7
    s_mul_i32 s3, s3, 40
    s_lshr_b32 s2, s2, 3
    s_add_u32 s2, s2, s3
    s_load_dwordx16 s[36:51], s[0:1], 0
    s_load_dwordx2 s[52:53], s[0:1], 104
    s_waitcnt lgkmcnt(0)
    s_mov_b32 s4, s36
    s_mov_b32 s5, s37
    s_mov_b32 s6, 0x280000
    s_mov_b32 s7, 0x00020000
    s_mov_b32 s8, s38
    s_mov_b32 s9, s39
    s_mov_b32 s10, 0x28000
    s_mov_b32 s11, 0x00020000
    s_mov_b32 s12, s40
    s_mov_b32 s13, s41
    s_mov_b32 s14, 0x28000
    s_mov_b32 s15, 0x00020000
    s_mov_b32 s20, s42
    s_mov_b32 s21, s43
    s_mov_b32 s22, 0x28000
    s_mov_b32 s23, 0x00020000
    s_mov_b32 s24, s44
    s_mov_b32 s25, s45
    s_mov_b32 s26, 0x28000
    s_mov_b32 s27, 0x00020000
    s_mov_b32 s28, s46
    s_mov_b32 s29, s47
    s_mov_b32 s30, 0x500
    s_mov_b32 s31, 0x00020000
    s_mov_b32 s32, s48
    s_mov_b32 s33, s49
    s_mov_b32 s34, 0x500
    s_mov_b32 s35, 0x00020000
    s_mov_b32 s16, s52
    s_mov_b32 s17, s53
    s_mov_b32 s18, 0xa80000
    s_mov_b32 s19, 0x00020000
    v_and_b32 v2, 63, v0
    v_lshrrev_b32 v4, 6, v0
    s_nop 0
    v_readfirstlane_b32 s55, v4
    s_nop 4
    s_lshr_b32 s60, s55, 2
    s_and_b32 s55, s55, 3
    s_lshl_b32 s61, s2, 1
    s_add_u32 s54, s61, s60
    s_mul_i32 s60, s60, 36608
    v_and_b32 v1, 255, v0
    v_mul_u32_u24 v22, 1280, v0
    s_lshl_b32 s62, s61, 1
    v_and_b32 v4, 127, v0
    v_lshlrev_b32 v4, 1, v4
    s_lshl_b32 s56, s54, 8
    buffer_load_ushort v23, v4, s[8:11], s56 offen
    buffer_load_ushort v24, v4, s[12:15], s56 offen
    buffer_load_ushort v25, v4, s[20:23], s56 offen
    buffer_load_ushort v26, v4, s[24:27], s56 offen
    v_mov_b32 v5, 0
    s_lshl_b32 s57, s54, 1
    buffer_load_ushort v27, v5, s[28:31], s57 offen
    buffer_load_ushort v12, v5, s[32:35], s57 offen
    v_mov_b32 v28, 0
    v_mov_b32 v29, 0
    v_mov_b32 v30, 0
    v_mov_b32 v31, 0
    v_cmp_gt_u32 vcc, 64, v1
    s_and_saveexec_b64 s[58:59], vcc
    v_lshrrev_b32 v5, 4, v1
    v_mul_u32_u24 v5, 4256, v5
    v_and_b32 v6, 15, v1
    v_lshl_add_u32 v5, v6, 4, v5
    v_add_u32 v5, s60, v5
    ds_write_b128 v5, v[28:31] offset:9216
    s_mov_b64 exec, s[58:59]
    s_waitcnt vmcnt(0)
    v_lshlrev_b32 v12, 16, v12
    v_lshlrev_b32 v27, 16, v27
    v_mul_f32 v27, 0x3fb8aa3b, v27
    v_exp_f32 v27, v27
    s_nop 0
    v_cvt_pk_bf16_f32 v27, v27, v27
    v_lshlrev_b32 v27, 16, v27
    v_lshlrev_b32 v23, 16, v23
    v_lshlrev_b32 v24, 16, v24
    v_lshlrev_b32 v25, 16, v25
    v_lshlrev_b32 v26, 16, v26
    v_mul_f32 v32, 0x3fb8aa3b, v23
    v_exp_f32 v32, v32
    s_nop 0
    v_cvt_pk_bf16_f32 v32, v32, v32
    v_lshlrev_b32 v32, 16, v32
    v_mul_f32 v32, v32, v27
    v_mul_f32 v32, 0xbfb8aa3b, v32
    v_mul_f32 v33, v24, v27
    v_mul_f32 v33, 0x3e22f983, v33
    v_mul_f32 v34, v25, v27
    v_add_f32 v34, v34, v34
    v_mul_f32 v35, v26, v27
    v_add_f32 v35, v35, v35
    v_mul_f32 v18, 0x43800000, v32
    v_mul_f32 v19, 0x43800000, v33
    v_exp_f32 v18, v18
    v_fract_f32 v19, v19
    v_cos_f32 v20, v19
    v_sin_f32 v19, v19
    s_nop 0
    v_mul_f32 v44, v18, v20
    v_mul_f32 v45, v18, v19
    v_pk_mul_f32 v[36:37], v[34:35], v[44:45] op_sel_hi:[0,1]
    v_pk_fma_f32 v[36:37], v[34:35], v[44:45], v[36:37] op_sel:[1,1,0] op_sel_hi:[1,0,1] neg_lo:[1,0,0]
    v_mul_f32 v18, 0x44000000, v32
    v_mul_f32 v19, 0x44000000, v33
    v_exp_f32 v18, v18
    v_fract_f32 v19, v19
    v_cos_f32 v20, v19
    v_sin_f32 v19, v19
    s_nop 0
    v_mul_f32 v44, v18, v20
    v_mul_f32 v45, v18, v19
    v_pk_mul_f32 v[38:39], v[34:35], v[44:45] op_sel_hi:[0,1]
    v_pk_fma_f32 v[38:39], v[34:35], v[44:45], v[38:39] op_sel:[1,1,0] op_sel_hi:[1,0,1] neg_lo:[1,0,0]
    v_mul_f32 v18, 0x44800000, v32
    v_mul_f32 v19, 0x44800000, v33
    v_exp_f32 v18, v18
    v_fract_f32 v19, v19
    v_cos_f32 v20, v19
    v_sin_f32 v19, v19
    s_nop 0
    v_mul_f32 v44, v18, v20
    v_mul_f32 v45, v18, v19
    v_pk_mul_f32 v[40:41], v[34:35], v[44:45] op_sel_hi:[0,1]
    v_pk_fma_f32 v[40:41], v[34:35], v[44:45], v[40:41] op_sel:[1,1,0] op_sel_hi:[1,0,1] neg_lo:[1,0,0]
    v_and_b32 v4, 127, v0
    v_mul_u32_u24 v4, 48, v4
    v_add_u32 v4, s60, v4
    v_cmp_gt_u32 vcc, 128, v1
    s_and_saveexec_b64 s[58:59], vcc
    ds_write_b128 v4, v[32:35] offset:0
    ds_write_b128 v4, v[36:39] offset:16
    ds_write_b64 v4, v[40:41] offset:32
    s_mov_b64 exec, s[58:59]
    s_waitcnt lgkmcnt(0)
    s_barrier
    v_mov_b32 v88, 0
    v_mov_b32 v89, 0
    v_mov_b32 v90, 0
    v_mov_b32 v91, 0
    v_mov_b32 v92, 0
    v_mov_b32 v93, 0
    v_mov_b32 v94, 0
    v_mov_b32 v95, 0
    v_mov_b32 v96, 0
    v_mov_b32 v97, 0
    v_mov_b32 v98, 0
    v_mov_b32 v99, 0
    v_mov_b32 v100, 0
    v_mov_b32 v101, 0
    v_mov_b32 v102, 0
    v_mov_b32 v103, 0
    v_and_b32 v104, 15, v2
    v_cvt_f32_u32 v104, v104
    v_mul_f32 v105, 0x41800000, v104
    v_lshrrev_b32 v106, 4, v2
    v_mul_u32_u24 v106, 192, v106
    s_mul_i32 s56, s55, 1536
    s_add_u32 s56, s56, s60
    v_add_u32 v106, s56, v106
    ds_read_b128 v[108:111], v106 offset:0
    ds_read_b128 v[112:115], v106 offset:16
    ds_read_b64 v[116:117], v106 offset:32
    buffer_load_dword v13, v22, s[4:7], s62 offen
    s_add_u32 s62, s62, 655360
    s_waitcnt lgkmcnt(0)
    v_mul_f32 v18, v104, v108
    v_mul_f32 v19, v104, v109
    v_exp_f32 v18, v18
    v_fract_f32 v19, v19
    v_cos_f32 v20, v19
    v_sin_f32 v19, v19
    s_nop 0
    v_mul_f32 v120, v18, v20
    v_mul_f32 v121, v18, v19
    v_cvt_pk_bf16_f32 v56, v120, v121
    v_lshlrev_b32 v18, 16, v56
    v_and_b32 v19, 0xffff0000, v56
    v_sub_f32 v18, v120, v18
    v_sub_f32 v19, v121, v19
    v_cvt_pk_bf16_f32 v72, v18, v19
    v_pk_mul_f32 v[122:123], v[120:121], v[120:121] op_sel_hi:[0,1]
    v_pk_fma_f32 v[122:123], v[120:121], v[120:121], v[122:123] op_sel:[1,1,0] op_sel_hi:[0,1,1] neg_lo:[1,0,0]
    v_cvt_pk_bf16_f32 v60, v122, v123
    v_lshlrev_b32 v18, 16, v60
    v_and_b32 v19, 0xffff0000, v60
    v_sub_f32 v18, v122, v18
    v_sub_f32 v19, v123, v19
    v_cvt_pk_bf16_f32 v76, v18, v19
    v_pk_mul_f32 v[120:121], v[122:123], v[122:123] op_sel_hi:[0,1]
    v_pk_fma_f32 v[120:121], v[122:123], v[122:123], v[120:121] op_sel:[1,1,0] op_sel_hi:[0,1,1] neg_lo:[1,0,0]
    v_cvt_pk_bf16_f32 v64, v120, v121
    v_lshlrev_b32 v18, 16, v64
    v_and_b32 v19, 0xffff0000, v64
    v_sub_f32 v18, v120, v18
    v_sub_f32 v19, v121, v19
    v_cvt_pk_bf16_f32 v80, v18, v19
    v_pk_mul_f32 v[122:123], v[120:121], v[120:121] op_sel_hi:[0,1]
    v_pk_fma_f32 v[122:123], v[120:121], v[120:121], v[122:123] op_sel:[1,1,0] op_sel_hi:[0,1,1] neg_lo:[1,0,0]
    v_cvt_pk_bf16_f32 v68, v122, v123
    v_lshlrev_b32 v18, 16, v68
    v_and_b32 v19, 0xffff0000, v68
    v_sub_f32 v18, v122, v18
    v_sub_f32 v19, v123, v19
    v_cvt_pk_bf16_f32 v84, v18, v19
    v_mul_f32 v18, v105, v108
    v_mul_f32 v19, v105, v109
    v_exp_f32 v18, v18
    v_fract_f32 v19, v19
    v_cos_f32 v20, v19
    v_sin_f32 v19, v19
    s_nop 0
    v_mul_f32 v122, v18, v20
    v_mul_f32 v123, v18, v19
    v_pk_mul_f32 v[124:125], v[110:111], v[122:123] op_sel_hi:[0,1]
    v_pk_fma_f32 v[124:125], v[110:111], v[122:123], v[124:125] op_sel:[1,1,0] op_sel_hi:[1,0,1] neg_lo:[1,0,0]
    v_cvt_pk_bf16_f32 v24, v124, -v125
    v_lshlrev_b32 v18, 16, v24
    v_and_b32 v19, 0xffff0000, v24
    v_sub_f32 v18, v124, v18
    v_sub_f32 v19, -v125, v19
    v_cvt_pk_bf16_f32 v40, v18, v19
    v_pk_mul_f32 v[120:121], v[122:123], v[122:123] op_sel_hi:[0,1]
    v_pk_fma_f32 v[120:121], v[122:123], v[122:123], v[120:121] op_sel:[1,1,0] op_sel_hi:[0,1,1] neg_lo:[1,0,0]
    v_pk_mul_f32 v[124:125], v[112:113], v[120:121] op_sel_hi:[0,1]
    v_pk_fma_f32 v[124:125], v[112:113], v[120:121], v[124:125] op_sel:[1,1,0] op_sel_hi:[1,0,1] neg_lo:[1,0,0]
    v_cvt_pk_bf16_f32 v28, v124, -v125
    v_lshlrev_b32 v18, 16, v28
    v_and_b32 v19, 0xffff0000, v28
    v_sub_f32 v18, v124, v18
    v_sub_f32 v19, -v125, v19
    v_cvt_pk_bf16_f32 v44, v18, v19
    v_pk_mul_f32 v[122:123], v[120:121], v[120:121] op_sel_hi:[0,1]
    v_pk_fma_f32 v[122:123], v[120:121], v[120:121], v[122:123] op_sel:[1,1,0] op_sel_hi:[0,1,1] neg_lo:[1,0,0]
    v_pk_mul_f32 v[124:125], v[114:115], v[122:123] op_sel_hi:[0,1]
    v_pk_fma_f32 v[124:125], v[114:115], v[122:123], v[124:125] op_sel:[1,1,0] op_sel_hi:[1,0,1] neg_lo:[1,0,0]
    v_cvt_pk_bf16_f32 v32, v124, -v125
    v_lshlrev_b32 v18, 16, v32
    v_and_b32 v19, 0xffff0000, v32
    v_sub_f32 v18, v124, v18
    v_sub_f32 v19, -v125, v19
    v_cvt_pk_bf16_f32 v48, v18, v19
    v_pk_mul_f32 v[120:121], v[122:123], v[122:123] op_sel_hi:[0,1]
    v_pk_fma_f32 v[120:121], v[122:123], v[122:123], v[120:121] op_sel:[1,1,0] op_sel_hi:[0,1,1] neg_lo:[1,0,0]
    v_pk_mul_f32 v[124:125], v[116:117], v[120:121] op_sel_hi:[0,1]
    v_pk_fma_f32 v[124:125], v[116:117], v[120:121], v[124:125] op_sel:[1,1,0] op_sel_hi:[1,0,1] neg_lo:[1,0,0]
    v_cvt_pk_bf16_f32 v36, v124, -v125
    v_lshlrev_b32 v18, 16, v36
    v_and_b32 v19, 0xffff0000, v36
    v_sub_f32 v18, v124, v18
    v_sub_f32 v19, -v125, v19
    v_cvt_pk_bf16_f32 v52, v18, v19
    ds_read_b128 v[108:111], v106 offset:48
    ds_read_b128 v[112:115], v106 offset:64
    ds_read_b64 v[116:117], v106 offset:80
    s_waitcnt lgkmcnt(0)
    v_mul_f32 v18, v104, v108
    v_mul_f32 v19, v104, v109
    v_exp_f32 v18, v18
    v_fract_f32 v19, v19
    v_cos_f32 v20, v19
    v_sin_f32 v19, v19
    s_nop 0
    v_mul_f32 v120, v18, v20
    v_mul_f32 v121, v18, v19
    v_cvt_pk_bf16_f32 v57, v120, v121
    v_lshlrev_b32 v18, 16, v57
    v_and_b32 v19, 0xffff0000, v57
    v_sub_f32 v18, v120, v18
    v_sub_f32 v19, v121, v19
    v_cvt_pk_bf16_f32 v73, v18, v19
    v_pk_mul_f32 v[122:123], v[120:121], v[120:121] op_sel_hi:[0,1]
    v_pk_fma_f32 v[122:123], v[120:121], v[120:121], v[122:123] op_sel:[1,1,0] op_sel_hi:[0,1,1] neg_lo:[1,0,0]
    v_cvt_pk_bf16_f32 v61, v122, v123
    v_lshlrev_b32 v18, 16, v61
    v_and_b32 v19, 0xffff0000, v61
    v_sub_f32 v18, v122, v18
    v_sub_f32 v19, v123, v19
    v_cvt_pk_bf16_f32 v77, v18, v19
    v_pk_mul_f32 v[120:121], v[122:123], v[122:123] op_sel_hi:[0,1]
    v_pk_fma_f32 v[120:121], v[122:123], v[122:123], v[120:121] op_sel:[1,1,0] op_sel_hi:[0,1,1] neg_lo:[1,0,0]
    v_cvt_pk_bf16_f32 v65, v120, v121
    v_lshlrev_b32 v18, 16, v65
    v_and_b32 v19, 0xffff0000, v65
    v_sub_f32 v18, v120, v18
    v_sub_f32 v19, v121, v19
    v_cvt_pk_bf16_f32 v81, v18, v19
    v_pk_mul_f32 v[122:123], v[120:121], v[120:121] op_sel_hi:[0,1]
    v_pk_fma_f32 v[122:123], v[120:121], v[120:121], v[122:123] op_sel:[1,1,0] op_sel_hi:[0,1,1] neg_lo:[1,0,0]
    v_cvt_pk_bf16_f32 v69, v122, v123
    v_lshlrev_b32 v18, 16, v69
    v_and_b32 v19, 0xffff0000, v69
    v_sub_f32 v18, v122, v18
    v_sub_f32 v19, v123, v19
    v_cvt_pk_bf16_f32 v85, v18, v19
    v_mul_f32 v18, v105, v108
    v_mul_f32 v19, v105, v109
    v_exp_f32 v18, v18
    v_fract_f32 v19, v19
    v_cos_f32 v20, v19
    v_sin_f32 v19, v19
    s_nop 0
    v_mul_f32 v122, v18, v20
    v_mul_f32 v123, v18, v19
    v_pk_mul_f32 v[124:125], v[110:111], v[122:123] op_sel_hi:[0,1]
    v_pk_fma_f32 v[124:125], v[110:111], v[122:123], v[124:125] op_sel:[1,1,0] op_sel_hi:[1,0,1] neg_lo:[1,0,0]
    v_cvt_pk_bf16_f32 v25, v124, -v125
    v_lshlrev_b32 v18, 16, v25
    v_and_b32 v19, 0xffff0000, v25
    v_sub_f32 v18, v124, v18
    v_sub_f32 v19, -v125, v19
    v_cvt_pk_bf16_f32 v41, v18, v19
    v_pk_mul_f32 v[120:121], v[122:123], v[122:123] op_sel_hi:[0,1]
    v_pk_fma_f32 v[120:121], v[122:123], v[122:123], v[120:121] op_sel:[1,1,0] op_sel_hi:[0,1,1] neg_lo:[1,0,0]
    v_pk_mul_f32 v[124:125], v[112:113], v[120:121] op_sel_hi:[0,1]
    v_pk_fma_f32 v[124:125], v[112:113], v[120:121], v[124:125] op_sel:[1,1,0] op_sel_hi:[1,0,1] neg_lo:[1,0,0]
    v_cvt_pk_bf16_f32 v29, v124, -v125
    v_lshlrev_b32 v18, 16, v29
    v_and_b32 v19, 0xffff0000, v29
    v_sub_f32 v18, v124, v18
    v_sub_f32 v19, -v125, v19
    v_cvt_pk_bf16_f32 v45, v18, v19
    v_pk_mul_f32 v[122:123], v[120:121], v[120:121] op_sel_hi:[0,1]
    v_pk_fma_f32 v[122:123], v[120:121], v[120:121], v[122:123] op_sel:[1,1,0] op_sel_hi:[0,1,1] neg_lo:[1,0,0]
    v_pk_mul_f32 v[124:125], v[114:115], v[122:123] op_sel_hi:[0,1]
    v_pk_fma_f32 v[124:125], v[114:115], v[122:123], v[124:125] op_sel:[1,1,0] op_sel_hi:[1,0,1] neg_lo:[1,0,0]
    v_cvt_pk_bf16_f32 v33, v124, -v125
    v_lshlrev_b32 v18, 16, v33
    v_and_b32 v19, 0xffff0000, v33
    v_sub_f32 v18, v124, v18
    v_sub_f32 v19, -v125, v19
    v_cvt_pk_bf16_f32 v49, v18, v19
    v_pk_mul_f32 v[120:121], v[122:123], v[122:123] op_sel_hi:[0,1]
    v_pk_fma_f32 v[120:121], v[122:123], v[122:123], v[120:121] op_sel:[1,1,0] op_sel_hi:[0,1,1] neg_lo:[1,0,0]
    v_pk_mul_f32 v[124:125], v[116:117], v[120:121] op_sel_hi:[0,1]
    v_pk_fma_f32 v[124:125], v[116:117], v[120:121], v[124:125] op_sel:[1,1,0] op_sel_hi:[1,0,1] neg_lo:[1,0,0]
    v_cvt_pk_bf16_f32 v37, v124, -v125
    v_lshlrev_b32 v18, 16, v37
    v_and_b32 v19, 0xffff0000, v37
    v_sub_f32 v18, v124, v18
    v_sub_f32 v19, -v125, v19
    v_cvt_pk_bf16_f32 v53, v18, v19
    ds_read_b128 v[108:111], v106 offset:96
    ds_read_b128 v[112:115], v106 offset:112
    ds_read_b64 v[116:117], v106 offset:128
    buffer_load_dword v14, v22, s[4:7], s62 offen
    s_add_u32 s62, s62, 655360
    s_waitcnt lgkmcnt(0)
    v_mul_f32 v18, v104, v108
    v_mul_f32 v19, v104, v109
    v_exp_f32 v18, v18
    v_fract_f32 v19, v19
    v_cos_f32 v20, v19
    v_sin_f32 v19, v19
    s_nop 0
    v_mul_f32 v120, v18, v20
    v_mul_f32 v121, v18, v19
    v_cvt_pk_bf16_f32 v58, v120, v121
    v_lshlrev_b32 v18, 16, v58
    v_and_b32 v19, 0xffff0000, v58
    v_sub_f32 v18, v120, v18
    v_sub_f32 v19, v121, v19
    v_cvt_pk_bf16_f32 v74, v18, v19
    v_pk_mul_f32 v[122:123], v[120:121], v[120:121] op_sel_hi:[0,1]
    v_pk_fma_f32 v[122:123], v[120:121], v[120:121], v[122:123] op_sel:[1,1,0] op_sel_hi:[0,1,1] neg_lo:[1,0,0]
    v_cvt_pk_bf16_f32 v62, v122, v123
    v_lshlrev_b32 v18, 16, v62
    v_and_b32 v19, 0xffff0000, v62
    v_sub_f32 v18, v122, v18
    v_sub_f32 v19, v123, v19
    v_cvt_pk_bf16_f32 v78, v18, v19
    v_pk_mul_f32 v[120:121], v[122:123], v[122:123] op_sel_hi:[0,1]
    v_pk_fma_f32 v[120:121], v[122:123], v[122:123], v[120:121] op_sel:[1,1,0] op_sel_hi:[0,1,1] neg_lo:[1,0,0]
    v_cvt_pk_bf16_f32 v66, v120, v121
    v_lshlrev_b32 v18, 16, v66
    v_and_b32 v19, 0xffff0000, v66
    v_sub_f32 v18, v120, v18
    v_sub_f32 v19, v121, v19
    v_cvt_pk_bf16_f32 v82, v18, v19
    v_pk_mul_f32 v[122:123], v[120:121], v[120:121] op_sel_hi:[0,1]
    v_pk_fma_f32 v[122:123], v[120:121], v[120:121], v[122:123] op_sel:[1,1,0] op_sel_hi:[0,1,1] neg_lo:[1,0,0]
    v_cvt_pk_bf16_f32 v70, v122, v123
    v_lshlrev_b32 v18, 16, v70
    v_and_b32 v19, 0xffff0000, v70
    v_sub_f32 v18, v122, v18
    v_sub_f32 v19, v123, v19
    v_cvt_pk_bf16_f32 v86, v18, v19
    v_mul_f32 v18, v105, v108
    v_mul_f32 v19, v105, v109
    v_exp_f32 v18, v18
    v_fract_f32 v19, v19
    v_cos_f32 v20, v19
    v_sin_f32 v19, v19
    s_nop 0
    v_mul_f32 v122, v18, v20
    v_mul_f32 v123, v18, v19
    v_pk_mul_f32 v[124:125], v[110:111], v[122:123] op_sel_hi:[0,1]
    v_pk_fma_f32 v[124:125], v[110:111], v[122:123], v[124:125] op_sel:[1,1,0] op_sel_hi:[1,0,1] neg_lo:[1,0,0]
    v_cvt_pk_bf16_f32 v26, v124, -v125
    v_lshlrev_b32 v18, 16, v26
    v_and_b32 v19, 0xffff0000, v26
    v_sub_f32 v18, v124, v18
    v_sub_f32 v19, -v125, v19
    v_cvt_pk_bf16_f32 v42, v18, v19
    v_pk_mul_f32 v[120:121], v[122:123], v[122:123] op_sel_hi:[0,1]
    v_pk_fma_f32 v[120:121], v[122:123], v[122:123], v[120:121] op_sel:[1,1,0] op_sel_hi:[0,1,1] neg_lo:[1,0,0]
    v_pk_mul_f32 v[124:125], v[112:113], v[120:121] op_sel_hi:[0,1]
    v_pk_fma_f32 v[124:125], v[112:113], v[120:121], v[124:125] op_sel:[1,1,0] op_sel_hi:[1,0,1] neg_lo:[1,0,0]
    v_cvt_pk_bf16_f32 v30, v124, -v125
    v_lshlrev_b32 v18, 16, v30
    v_and_b32 v19, 0xffff0000, v30
    v_sub_f32 v18, v124, v18
    v_sub_f32 v19, -v125, v19
    v_cvt_pk_bf16_f32 v46, v18, v19
    v_pk_mul_f32 v[122:123], v[120:121], v[120:121] op_sel_hi:[0,1]
    v_pk_fma_f32 v[122:123], v[120:121], v[120:121], v[122:123] op_sel:[1,1,0] op_sel_hi:[0,1,1] neg_lo:[1,0,0]
    v_pk_mul_f32 v[124:125], v[114:115], v[122:123] op_sel_hi:[0,1]
    v_pk_fma_f32 v[124:125], v[114:115], v[122:123], v[124:125] op_sel:[1,1,0] op_sel_hi:[1,0,1] neg_lo:[1,0,0]
    v_cvt_pk_bf16_f32 v34, v124, -v125
    v_lshlrev_b32 v18, 16, v34
    v_and_b32 v19, 0xffff0000, v34
    v_sub_f32 v18, v124, v18
    v_sub_f32 v19, -v125, v19
    v_cvt_pk_bf16_f32 v50, v18, v19
    v_pk_mul_f32 v[120:121], v[122:123], v[122:123] op_sel_hi:[0,1]
    v_pk_fma_f32 v[120:121], v[122:123], v[122:123], v[120:121] op_sel:[1,1,0] op_sel_hi:[0,1,1] neg_lo:[1,0,0]
    v_pk_mul_f32 v[124:125], v[116:117], v[120:121] op_sel_hi:[0,1]
    v_pk_fma_f32 v[124:125], v[116:117], v[120:121], v[124:125] op_sel:[1,1,0] op_sel_hi:[1,0,1] neg_lo:[1,0,0]
    v_cvt_pk_bf16_f32 v38, v124, -v125
    v_lshlrev_b32 v18, 16, v38
    v_and_b32 v19, 0xffff0000, v38
    v_sub_f32 v18, v124, v18
    v_sub_f32 v19, -v125, v19
    v_cvt_pk_bf16_f32 v54, v18, v19
    ds_read_b128 v[108:111], v106 offset:144
    ds_read_b128 v[112:115], v106 offset:160
    ds_read_b64 v[116:117], v106 offset:176
    s_waitcnt lgkmcnt(0)
    v_mul_f32 v18, v104, v108
    v_mul_f32 v19, v104, v109
    v_exp_f32 v18, v18
    v_fract_f32 v19, v19
    v_cos_f32 v20, v19
    v_sin_f32 v19, v19
    s_nop 0
    v_mul_f32 v120, v18, v20
    v_mul_f32 v121, v18, v19
    v_cvt_pk_bf16_f32 v59, v120, v121
    v_lshlrev_b32 v18, 16, v59
    v_and_b32 v19, 0xffff0000, v59
    v_sub_f32 v18, v120, v18
    v_sub_f32 v19, v121, v19
    v_cvt_pk_bf16_f32 v75, v18, v19
    v_pk_mul_f32 v[122:123], v[120:121], v[120:121] op_sel_hi:[0,1]
    v_pk_fma_f32 v[122:123], v[120:121], v[120:121], v[122:123] op_sel:[1,1,0] op_sel_hi:[0,1,1] neg_lo:[1,0,0]
    v_cvt_pk_bf16_f32 v63, v122, v123
    v_lshlrev_b32 v18, 16, v63
    v_and_b32 v19, 0xffff0000, v63
    v_sub_f32 v18, v122, v18
    v_sub_f32 v19, v123, v19
    v_cvt_pk_bf16_f32 v79, v18, v19
    v_pk_mul_f32 v[120:121], v[122:123], v[122:123] op_sel_hi:[0,1]
    v_pk_fma_f32 v[120:121], v[122:123], v[122:123], v[120:121] op_sel:[1,1,0] op_sel_hi:[0,1,1] neg_lo:[1,0,0]
    v_cvt_pk_bf16_f32 v67, v120, v121
    v_lshlrev_b32 v18, 16, v67
    v_and_b32 v19, 0xffff0000, v67
    v_sub_f32 v18, v120, v18
    v_sub_f32 v19, v121, v19
    v_cvt_pk_bf16_f32 v83, v18, v19
    v_pk_mul_f32 v[122:123], v[120:121], v[120:121] op_sel_hi:[0,1]
    v_pk_fma_f32 v[122:123], v[120:121], v[120:121], v[122:123] op_sel:[1,1,0] op_sel_hi:[0,1,1] neg_lo:[1,0,0]
    v_cvt_pk_bf16_f32 v71, v122, v123
    v_lshlrev_b32 v18, 16, v71
    v_and_b32 v19, 0xffff0000, v71
    v_sub_f32 v18, v122, v18
    v_sub_f32 v19, v123, v19
    v_cvt_pk_bf16_f32 v87, v18, v19
    v_mul_f32 v18, v105, v108
    v_mul_f32 v19, v105, v109
    v_exp_f32 v18, v18
    v_fract_f32 v19, v19
    v_cos_f32 v20, v19
    v_sin_f32 v19, v19
    s_nop 0
    v_mul_f32 v122, v18, v20
    v_mul_f32 v123, v18, v19
    v_pk_mul_f32 v[124:125], v[110:111], v[122:123] op_sel_hi:[0,1]
    v_pk_fma_f32 v[124:125], v[110:111], v[122:123], v[124:125] op_sel:[1,1,0] op_sel_hi:[1,0,1] neg_lo:[1,0,0]
    v_cvt_pk_bf16_f32 v27, v124, -v125
    v_lshlrev_b32 v18, 16, v27
    v_and_b32 v19, 0xffff0000, v27
    v_sub_f32 v18, v124, v18
    v_sub_f32 v19, -v125, v19
    v_cvt_pk_bf16_f32 v43, v18, v19
    v_pk_mul_f32 v[120:121], v[122:123], v[122:123] op_sel_hi:[0,1]
    v_pk_fma_f32 v[120:121], v[122:123], v[122:123], v[120:121] op_sel:[1,1,0] op_sel_hi:[0,1,1] neg_lo:[1,0,0]
    v_pk_mul_f32 v[124:125], v[112:113], v[120:121] op_sel_hi:[0,1]
    v_pk_fma_f32 v[124:125], v[112:113], v[120:121], v[124:125] op_sel:[1,1,0] op_sel_hi:[1,0,1] neg_lo:[1,0,0]
    v_cvt_pk_bf16_f32 v31, v124, -v125
    v_lshlrev_b32 v18, 16, v31
    v_and_b32 v19, 0xffff0000, v31
    v_sub_f32 v18, v124, v18
    v_sub_f32 v19, -v125, v19
    v_cvt_pk_bf16_f32 v47, v18, v19
    v_pk_mul_f32 v[122:123], v[120:121], v[120:121] op_sel_hi:[0,1]
    v_pk_fma_f32 v[122:123], v[120:121], v[120:121], v[122:123] op_sel:[1,1,0] op_sel_hi:[0,1,1] neg_lo:[1,0,0]
    v_pk_mul_f32 v[124:125], v[114:115], v[122:123] op_sel_hi:[0,1]
    v_pk_fma_f32 v[124:125], v[114:115], v[122:123], v[124:125] op_sel:[1,1,0] op_sel_hi:[1,0,1] neg_lo:[1,0,0]
    v_cvt_pk_bf16_f32 v35, v124, -v125
    v_lshlrev_b32 v18, 16, v35
    v_and_b32 v19, 0xffff0000, v35
    v_sub_f32 v18, v124, v18
    v_sub_f32 v19, -v125, v19
    v_cvt_pk_bf16_f32 v51, v18, v19
    v_pk_mul_f32 v[120:121], v[122:123], v[122:123] op_sel_hi:[0,1]
    v_pk_fma_f32 v[120:121], v[122:123], v[122:123], v[120:121] op_sel:[1,1,0] op_sel_hi:[0,1,1] neg_lo:[1,0,0]
    v_pk_mul_f32 v[124:125], v[116:117], v[120:121] op_sel_hi:[0,1]
    v_pk_fma_f32 v[124:125], v[116:117], v[120:121], v[124:125] op_sel:[1,1,0] op_sel_hi:[1,0,1] neg_lo:[1,0,0]
    v_cvt_pk_bf16_f32 v39, v124, -v125
    v_lshlrev_b32 v18, 16, v39
    v_and_b32 v19, 0xffff0000, v39
    v_sub_f32 v18, v124, v18
    v_sub_f32 v19, -v125, v19
    v_cvt_pk_bf16_f32 v55, v18, v19
    s_nop 1
    v_mfma_f32_16x16x32_bf16 v[88:91], v[24:27], v[56:59], v[88:91]
    v_mfma_f32_16x16x32_bf16 v[88:91], v[24:27], v[72:75], v[88:91]
    v_mfma_f32_16x16x32_bf16 v[88:91], v[40:43], v[56:59], v[88:91]
    v_mfma_f32_16x16x32_bf16 v[92:95], v[28:31], v[60:63], v[92:95]
    v_mfma_f32_16x16x32_bf16 v[92:95], v[28:31], v[76:79], v[92:95]
    v_mfma_f32_16x16x32_bf16 v[92:95], v[44:47], v[60:63], v[92:95]
    v_mfma_f32_16x16x32_bf16 v[96:99], v[32:35], v[64:67], v[96:99]
    v_mfma_f32_16x16x32_bf16 v[96:99], v[32:35], v[80:83], v[96:99]
    v_mfma_f32_16x16x32_bf16 v[96:99], v[48:51], v[64:67], v[96:99]
    v_mfma_f32_16x16x32_bf16 v[100:103], v[36:39], v[68:71], v[100:103]
    v_mfma_f32_16x16x32_bf16 v[100:103], v[36:39], v[84:87], v[100:103]
    v_mfma_f32_16x16x32_bf16 v[100:103], v[52:55], v[68:71], v[100:103]
    ds_read_b128 v[108:111], v106 offset:768
    ds_read_b128 v[112:115], v106 offset:784
    ds_read_b64 v[116:117], v106 offset:800
    buffer_load_dword v15, v22, s[4:7], s62 offen
    s_add_u32 s62, s62, 655360
    s_waitcnt lgkmcnt(0)
    v_mul_f32 v18, v104, v108
    v_mul_f32 v19, v104, v109
    v_exp_f32 v18, v18
    v_fract_f32 v19, v19
    v_cos_f32 v20, v19
    v_sin_f32 v19, v19
    s_nop 0
    v_mul_f32 v120, v18, v20
    v_mul_f32 v121, v18, v19
    v_cvt_pk_bf16_f32 v56, v120, v121
    v_lshlrev_b32 v18, 16, v56
    v_and_b32 v19, 0xffff0000, v56
    v_sub_f32 v18, v120, v18
    v_sub_f32 v19, v121, v19
    v_cvt_pk_bf16_f32 v72, v18, v19
    v_pk_mul_f32 v[122:123], v[120:121], v[120:121] op_sel_hi:[0,1]
    v_pk_fma_f32 v[122:123], v[120:121], v[120:121], v[122:123] op_sel:[1,1,0] op_sel_hi:[0,1,1] neg_lo:[1,0,0]
    v_cvt_pk_bf16_f32 v60, v122, v123
    v_lshlrev_b32 v18, 16, v60
    v_and_b32 v19, 0xffff0000, v60
    v_sub_f32 v18, v122, v18
    v_sub_f32 v19, v123, v19
    v_cvt_pk_bf16_f32 v76, v18, v19
    v_pk_mul_f32 v[120:121], v[122:123], v[122:123] op_sel_hi:[0,1]
    v_pk_fma_f32 v[120:121], v[122:123], v[122:123], v[120:121] op_sel:[1,1,0] op_sel_hi:[0,1,1] neg_lo:[1,0,0]
    v_cvt_pk_bf16_f32 v64, v120, v121
    v_lshlrev_b32 v18, 16, v64
    v_and_b32 v19, 0xffff0000, v64
    v_sub_f32 v18, v120, v18
    v_sub_f32 v19, v121, v19
    v_cvt_pk_bf16_f32 v80, v18, v19
    v_pk_mul_f32 v[122:123], v[120:121], v[120:121] op_sel_hi:[0,1]
    v_pk_fma_f32 v[122:123], v[120:121], v[120:121], v[122:123] op_sel:[1,1,0] op_sel_hi:[0,1,1] neg_lo:[1,0,0]
    v_cvt_pk_bf16_f32 v68, v122, v123
    v_lshlrev_b32 v18, 16, v68
    v_and_b32 v19, 0xffff0000, v68
    v_sub_f32 v18, v122, v18
    v_sub_f32 v19, v123, v19
    v_cvt_pk_bf16_f32 v84, v18, v19
    v_mul_f32 v18, v105, v108
    v_mul_f32 v19, v105, v109
    v_exp_f32 v18, v18
    v_fract_f32 v19, v19
    v_cos_f32 v20, v19
    v_sin_f32 v19, v19
    s_nop 0
    v_mul_f32 v122, v18, v20
    v_mul_f32 v123, v18, v19
    v_pk_mul_f32 v[124:125], v[110:111], v[122:123] op_sel_hi:[0,1]
    v_pk_fma_f32 v[124:125], v[110:111], v[122:123], v[124:125] op_sel:[1,1,0] op_sel_hi:[1,0,1] neg_lo:[1,0,0]
    v_cvt_pk_bf16_f32 v24, v124, -v125
    v_lshlrev_b32 v18, 16, v24
    v_and_b32 v19, 0xffff0000, v24
    v_sub_f32 v18, v124, v18
    v_sub_f32 v19, -v125, v19
    v_cvt_pk_bf16_f32 v40, v18, v19
    v_pk_mul_f32 v[120:121], v[122:123], v[122:123] op_sel_hi:[0,1]
    v_pk_fma_f32 v[120:121], v[122:123], v[122:123], v[120:121] op_sel:[1,1,0] op_sel_hi:[0,1,1] neg_lo:[1,0,0]
    v_pk_mul_f32 v[124:125], v[112:113], v[120:121] op_sel_hi:[0,1]
    v_pk_fma_f32 v[124:125], v[112:113], v[120:121], v[124:125] op_sel:[1,1,0] op_sel_hi:[1,0,1] neg_lo:[1,0,0]
    v_cvt_pk_bf16_f32 v28, v124, -v125
    v_lshlrev_b32 v18, 16, v28
    v_and_b32 v19, 0xffff0000, v28
    v_sub_f32 v18, v124, v18
    v_sub_f32 v19, -v125, v19
    v_cvt_pk_bf16_f32 v44, v18, v19
    v_pk_mul_f32 v[122:123], v[120:121], v[120:121] op_sel_hi:[0,1]
    v_pk_fma_f32 v[122:123], v[120:121], v[120:121], v[122:123] op_sel:[1,1,0] op_sel_hi:[0,1,1] neg_lo:[1,0,0]
    v_pk_mul_f32 v[124:125], v[114:115], v[122:123] op_sel_hi:[0,1]
    v_pk_fma_f32 v[124:125], v[114:115], v[122:123], v[124:125] op_sel:[1,1,0] op_sel_hi:[1,0,1] neg_lo:[1,0,0]
    v_cvt_pk_bf16_f32 v32, v124, -v125
    v_lshlrev_b32 v18, 16, v32
    v_and_b32 v19, 0xffff0000, v32
    v_sub_f32 v18, v124, v18
    v_sub_f32 v19, -v125, v19
    v_cvt_pk_bf16_f32 v48, v18, v19
    v_pk_mul_f32 v[120:121], v[122:123], v[122:123] op_sel_hi:[0,1]
    v_pk_fma_f32 v[120:121], v[122:123], v[122:123], v[120:121] op_sel:[1,1,0] op_sel_hi:[0,1,1] neg_lo:[1,0,0]
    v_pk_mul_f32 v[124:125], v[116:117], v[120:121] op_sel_hi:[0,1]
    v_pk_fma_f32 v[124:125], v[116:117], v[120:121], v[124:125] op_sel:[1,1,0] op_sel_hi:[1,0,1] neg_lo:[1,0,0]
    v_cvt_pk_bf16_f32 v36, v124, -v125
    v_lshlrev_b32 v18, 16, v36
    v_and_b32 v19, 0xffff0000, v36
    v_sub_f32 v18, v124, v18
    v_sub_f32 v19, -v125, v19
    v_cvt_pk_bf16_f32 v52, v18, v19
    ds_read_b128 v[108:111], v106 offset:816
    ds_read_b128 v[112:115], v106 offset:832
    ds_read_b64 v[116:117], v106 offset:848
    s_waitcnt lgkmcnt(0)
    v_mul_f32 v18, v104, v108
    v_mul_f32 v19, v104, v109
    v_exp_f32 v18, v18
    v_fract_f32 v19, v19
    v_cos_f32 v20, v19
    v_sin_f32 v19, v19
    s_nop 0
    v_mul_f32 v120, v18, v20
    v_mul_f32 v121, v18, v19
    v_cvt_pk_bf16_f32 v57, v120, v121
    v_lshlrev_b32 v18, 16, v57
    v_and_b32 v19, 0xffff0000, v57
    v_sub_f32 v18, v120, v18
    v_sub_f32 v19, v121, v19
    v_cvt_pk_bf16_f32 v73, v18, v19
    v_pk_mul_f32 v[122:123], v[120:121], v[120:121] op_sel_hi:[0,1]
    v_pk_fma_f32 v[122:123], v[120:121], v[120:121], v[122:123] op_sel:[1,1,0] op_sel_hi:[0,1,1] neg_lo:[1,0,0]
    v_cvt_pk_bf16_f32 v61, v122, v123
    v_lshlrev_b32 v18, 16, v61
    v_and_b32 v19, 0xffff0000, v61
    v_sub_f32 v18, v122, v18
    v_sub_f32 v19, v123, v19
    v_cvt_pk_bf16_f32 v77, v18, v19
    v_pk_mul_f32 v[120:121], v[122:123], v[122:123] op_sel_hi:[0,1]
    v_pk_fma_f32 v[120:121], v[122:123], v[122:123], v[120:121] op_sel:[1,1,0] op_sel_hi:[0,1,1] neg_lo:[1,0,0]
    v_cvt_pk_bf16_f32 v65, v120, v121
    v_lshlrev_b32 v18, 16, v65
    v_and_b32 v19, 0xffff0000, v65
    v_sub_f32 v18, v120, v18
    v_sub_f32 v19, v121, v19
    v_cvt_pk_bf16_f32 v81, v18, v19
    v_pk_mul_f32 v[122:123], v[120:121], v[120:121] op_sel_hi:[0,1]
    v_pk_fma_f32 v[122:123], v[120:121], v[120:121], v[122:123] op_sel:[1,1,0] op_sel_hi:[0,1,1] neg_lo:[1,0,0]
    v_cvt_pk_bf16_f32 v69, v122, v123
    v_lshlrev_b32 v18, 16, v69
    v_and_b32 v19, 0xffff0000, v69
    v_sub_f32 v18, v122, v18
    v_sub_f32 v19, v123, v19
    v_cvt_pk_bf16_f32 v85, v18, v19
    v_mul_f32 v18, v105, v108
    v_mul_f32 v19, v105, v109
    v_exp_f32 v18, v18
    v_fract_f32 v19, v19
    v_cos_f32 v20, v19
    v_sin_f32 v19, v19
    s_nop 0
    v_mul_f32 v122, v18, v20
    v_mul_f32 v123, v18, v19
    v_pk_mul_f32 v[124:125], v[110:111], v[122:123] op_sel_hi:[0,1]
    v_pk_fma_f32 v[124:125], v[110:111], v[122:123], v[124:125] op_sel:[1,1,0] op_sel_hi:[1,0,1] neg_lo:[1,0,0]
    v_cvt_pk_bf16_f32 v25, v124, -v125
    v_lshlrev_b32 v18, 16, v25
    v_and_b32 v19, 0xffff0000, v25
    v_sub_f32 v18, v124, v18
    v_sub_f32 v19, -v125, v19
    v_cvt_pk_bf16_f32 v41, v18, v19
    v_pk_mul_f32 v[120:121], v[122:123], v[122:123] op_sel_hi:[0,1]
    v_pk_fma_f32 v[120:121], v[122:123], v[122:123], v[120:121] op_sel:[1,1,0] op_sel_hi:[0,1,1] neg_lo:[1,0,0]
    v_pk_mul_f32 v[124:125], v[112:113], v[120:121] op_sel_hi:[0,1]
    v_pk_fma_f32 v[124:125], v[112:113], v[120:121], v[124:125] op_sel:[1,1,0] op_sel_hi:[1,0,1] neg_lo:[1,0,0]
    v_cvt_pk_bf16_f32 v29, v124, -v125
    v_lshlrev_b32 v18, 16, v29
    v_and_b32 v19, 0xffff0000, v29
    v_sub_f32 v18, v124, v18
    v_sub_f32 v19, -v125, v19
    v_cvt_pk_bf16_f32 v45, v18, v19
    v_pk_mul_f32 v[122:123], v[120:121], v[120:121] op_sel_hi:[0,1]
    v_pk_fma_f32 v[122:123], v[120:121], v[120:121], v[122:123] op_sel:[1,1,0] op_sel_hi:[0,1,1] neg_lo:[1,0,0]
    v_pk_mul_f32 v[124:125], v[114:115], v[122:123] op_sel_hi:[0,1]
    v_pk_fma_f32 v[124:125], v[114:115], v[122:123], v[124:125] op_sel:[1,1,0] op_sel_hi:[1,0,1] neg_lo:[1,0,0]
    v_cvt_pk_bf16_f32 v33, v124, -v125
    v_lshlrev_b32 v18, 16, v33
    v_and_b32 v19, 0xffff0000, v33
    v_sub_f32 v18, v124, v18
    v_sub_f32 v19, -v125, v19
    v_cvt_pk_bf16_f32 v49, v18, v19
    v_pk_mul_f32 v[120:121], v[122:123], v[122:123] op_sel_hi:[0,1]
    v_pk_fma_f32 v[120:121], v[122:123], v[122:123], v[120:121] op_sel:[1,1,0] op_sel_hi:[0,1,1] neg_lo:[1,0,0]
    v_pk_mul_f32 v[124:125], v[116:117], v[120:121] op_sel_hi:[0,1]
    v_pk_fma_f32 v[124:125], v[116:117], v[120:121], v[124:125] op_sel:[1,1,0] op_sel_hi:[1,0,1] neg_lo:[1,0,0]
    v_cvt_pk_bf16_f32 v37, v124, -v125
    v_lshlrev_b32 v18, 16, v37
    v_and_b32 v19, 0xffff0000, v37
    v_sub_f32 v18, v124, v18
    v_sub_f32 v19, -v125, v19
    v_cvt_pk_bf16_f32 v53, v18, v19
    ds_read_b128 v[108:111], v106 offset:864
    ds_read_b128 v[112:115], v106 offset:880
    ds_read_b64 v[116:117], v106 offset:896
    buffer_load_dword v16, v22, s[4:7], s62 offen
    s_add_u32 s62, s62, 655360
    s_waitcnt lgkmcnt(0)
    v_mul_f32 v18, v104, v108
    v_mul_f32 v19, v104, v109
    v_exp_f32 v18, v18
    v_fract_f32 v19, v19
    v_cos_f32 v20, v19
    v_sin_f32 v19, v19
    s_nop 0
    v_mul_f32 v120, v18, v20
    v_mul_f32 v121, v18, v19
    v_cvt_pk_bf16_f32 v58, v120, v121
    v_lshlrev_b32 v18, 16, v58
    v_and_b32 v19, 0xffff0000, v58
    v_sub_f32 v18, v120, v18
    v_sub_f32 v19, v121, v19
    v_cvt_pk_bf16_f32 v74, v18, v19
    v_pk_mul_f32 v[122:123], v[120:121], v[120:121] op_sel_hi:[0,1]
    v_pk_fma_f32 v[122:123], v[120:121], v[120:121], v[122:123] op_sel:[1,1,0] op_sel_hi:[0,1,1] neg_lo:[1,0,0]
    v_cvt_pk_bf16_f32 v62, v122, v123
    v_lshlrev_b32 v18, 16, v62
    v_and_b32 v19, 0xffff0000, v62
    v_sub_f32 v18, v122, v18
    v_sub_f32 v19, v123, v19
    v_cvt_pk_bf16_f32 v78, v18, v19
    v_pk_mul_f32 v[120:121], v[122:123], v[122:123] op_sel_hi:[0,1]
    v_pk_fma_f32 v[120:121], v[122:123], v[122:123], v[120:121] op_sel:[1,1,0] op_sel_hi:[0,1,1] neg_lo:[1,0,0]
    v_cvt_pk_bf16_f32 v66, v120, v121
    v_lshlrev_b32 v18, 16, v66
    v_and_b32 v19, 0xffff0000, v66
    v_sub_f32 v18, v120, v18
    v_sub_f32 v19, v121, v19
    v_cvt_pk_bf16_f32 v82, v18, v19
    v_pk_mul_f32 v[122:123], v[120:121], v[120:121] op_sel_hi:[0,1]
    v_pk_fma_f32 v[122:123], v[120:121], v[120:121], v[122:123] op_sel:[1,1,0] op_sel_hi:[0,1,1] neg_lo:[1,0,0]
    v_cvt_pk_bf16_f32 v70, v122, v123
    v_lshlrev_b32 v18, 16, v70
    v_and_b32 v19, 0xffff0000, v70
    v_sub_f32 v18, v122, v18
    v_sub_f32 v19, v123, v19
    v_cvt_pk_bf16_f32 v86, v18, v19
    v_mul_f32 v18, v105, v108
    v_mul_f32 v19, v105, v109
    v_exp_f32 v18, v18
    v_fract_f32 v19, v19
    v_cos_f32 v20, v19
    v_sin_f32 v19, v19
    s_nop 0
    v_mul_f32 v122, v18, v20
    v_mul_f32 v123, v18, v19
    v_pk_mul_f32 v[124:125], v[110:111], v[122:123] op_sel_hi:[0,1]
    v_pk_fma_f32 v[124:125], v[110:111], v[122:123], v[124:125] op_sel:[1,1,0] op_sel_hi:[1,0,1] neg_lo:[1,0,0]
    v_cvt_pk_bf16_f32 v26, v124, -v125
    v_lshlrev_b32 v18, 16, v26
    v_and_b32 v19, 0xffff0000, v26
    v_sub_f32 v18, v124, v18
    v_sub_f32 v19, -v125, v19
    v_cvt_pk_bf16_f32 v42, v18, v19
    v_pk_mul_f32 v[120:121], v[122:123], v[122:123] op_sel_hi:[0,1]
    v_pk_fma_f32 v[120:121], v[122:123], v[122:123], v[120:121] op_sel:[1,1,0] op_sel_hi:[0,1,1] neg_lo:[1,0,0]
    v_pk_mul_f32 v[124:125], v[112:113], v[120:121] op_sel_hi:[0,1]
    v_pk_fma_f32 v[124:125], v[112:113], v[120:121], v[124:125] op_sel:[1,1,0] op_sel_hi:[1,0,1] neg_lo:[1,0,0]
    v_cvt_pk_bf16_f32 v30, v124, -v125
    v_lshlrev_b32 v18, 16, v30
    v_and_b32 v19, 0xffff0000, v30
    v_sub_f32 v18, v124, v18
    v_sub_f32 v19, -v125, v19
    v_cvt_pk_bf16_f32 v46, v18, v19
    v_pk_mul_f32 v[122:123], v[120:121], v[120:121] op_sel_hi:[0,1]
    v_pk_fma_f32 v[122:123], v[120:121], v[120:121], v[122:123] op_sel:[1,1,0] op_sel_hi:[0,1,1] neg_lo:[1,0,0]
    v_pk_mul_f32 v[124:125], v[114:115], v[122:123] op_sel_hi:[0,1]
    v_pk_fma_f32 v[124:125], v[114:115], v[122:123], v[124:125] op_sel:[1,1,0] op_sel_hi:[1,0,1] neg_lo:[1,0,0]
    v_cvt_pk_bf16_f32 v34, v124, -v125
    v_lshlrev_b32 v18, 16, v34
    v_and_b32 v19, 0xffff0000, v34
    v_sub_f32 v18, v124, v18
    v_sub_f32 v19, -v125, v19
    v_cvt_pk_bf16_f32 v50, v18, v19
    v_pk_mul_f32 v[120:121], v[122:123], v[122:123] op_sel_hi:[0,1]
    v_pk_fma_f32 v[120:121], v[122:123], v[122:123], v[120:121] op_sel:[1,1,0] op_sel_hi:[0,1,1] neg_lo:[1,0,0]
    v_pk_mul_f32 v[124:125], v[116:117], v[120:121] op_sel_hi:[0,1]
    v_pk_fma_f32 v[124:125], v[116:117], v[120:121], v[124:125] op_sel:[1,1,0] op_sel_hi:[1,0,1] neg_lo:[1,0,0]
    v_cvt_pk_bf16_f32 v38, v124, -v125
    v_lshlrev_b32 v18, 16, v38
    v_and_b32 v19, 0xffff0000, v38
    v_sub_f32 v18, v124, v18
    v_sub_f32 v19, -v125, v19
    v_cvt_pk_bf16_f32 v54, v18, v19
    ds_read_b128 v[108:111], v106 offset:912
    ds_read_b128 v[112:115], v106 offset:928
    ds_read_b64 v[116:117], v106 offset:944
    s_waitcnt lgkmcnt(0)
    v_mul_f32 v18, v104, v108
    v_mul_f32 v19, v104, v109
    v_exp_f32 v18, v18
    v_fract_f32 v19, v19
    v_cos_f32 v20, v19
    v_sin_f32 v19, v19
    s_nop 0
    v_mul_f32 v120, v18, v20
    v_mul_f32 v121, v18, v19
    v_cvt_pk_bf16_f32 v59, v120, v121
    v_lshlrev_b32 v18, 16, v59
    v_and_b32 v19, 0xffff0000, v59
    v_sub_f32 v18, v120, v18
    v_sub_f32 v19, v121, v19
    v_cvt_pk_bf16_f32 v75, v18, v19
    v_pk_mul_f32 v[122:123], v[120:121], v[120:121] op_sel_hi:[0,1]
    v_pk_fma_f32 v[122:123], v[120:121], v[120:121], v[122:123] op_sel:[1,1,0] op_sel_hi:[0,1,1] neg_lo:[1,0,0]
    v_cvt_pk_bf16_f32 v63, v122, v123
    v_lshlrev_b32 v18, 16, v63
    v_and_b32 v19, 0xffff0000, v63
    v_sub_f32 v18, v122, v18
    v_sub_f32 v19, v123, v19
    v_cvt_pk_bf16_f32 v79, v18, v19
    v_pk_mul_f32 v[120:121], v[122:123], v[122:123] op_sel_hi:[0,1]
    v_pk_fma_f32 v[120:121], v[122:123], v[122:123], v[120:121] op_sel:[1,1,0] op_sel_hi:[0,1,1] neg_lo:[1,0,0]
    v_cvt_pk_bf16_f32 v67, v120, v121
    v_lshlrev_b32 v18, 16, v67
    v_and_b32 v19, 0xffff0000, v67
    v_sub_f32 v18, v120, v18
    v_sub_f32 v19, v121, v19
    v_cvt_pk_bf16_f32 v83, v18, v19
    v_pk_mul_f32 v[122:123], v[120:121], v[120:121] op_sel_hi:[0,1]
    v_pk_fma_f32 v[122:123], v[120:121], v[120:121], v[122:123] op_sel:[1,1,0] op_sel_hi:[0,1,1] neg_lo:[1,0,0]
    v_cvt_pk_bf16_f32 v71, v122, v123
    v_lshlrev_b32 v18, 16, v71
    v_and_b32 v19, 0xffff0000, v71
    v_sub_f32 v18, v122, v18
    v_sub_f32 v19, v123, v19
    v_cvt_pk_bf16_f32 v87, v18, v19
    v_mul_f32 v18, v105, v108
    v_mul_f32 v19, v105, v109
    v_exp_f32 v18, v18
    v_fract_f32 v19, v19
    v_cos_f32 v20, v19
    v_sin_f32 v19, v19
    s_nop 0
    v_mul_f32 v122, v18, v20
    v_mul_f32 v123, v18, v19
    v_pk_mul_f32 v[124:125], v[110:111], v[122:123] op_sel_hi:[0,1]
    v_pk_fma_f32 v[124:125], v[110:111], v[122:123], v[124:125] op_sel:[1,1,0] op_sel_hi:[1,0,1] neg_lo:[1,0,0]
    v_cvt_pk_bf16_f32 v27, v124, -v125
    v_lshlrev_b32 v18, 16, v27
    v_and_b32 v19, 0xffff0000, v27
    v_sub_f32 v18, v124, v18
    v_sub_f32 v19, -v125, v19
    v_cvt_pk_bf16_f32 v43, v18, v19
    v_pk_mul_f32 v[120:121], v[122:123], v[122:123] op_sel_hi:[0,1]
    v_pk_fma_f32 v[120:121], v[122:123], v[122:123], v[120:121] op_sel:[1,1,0] op_sel_hi:[0,1,1] neg_lo:[1,0,0]
    v_pk_mul_f32 v[124:125], v[112:113], v[120:121] op_sel_hi:[0,1]
    v_pk_fma_f32 v[124:125], v[112:113], v[120:121], v[124:125] op_sel:[1,1,0] op_sel_hi:[1,0,1] neg_lo:[1,0,0]
    v_cvt_pk_bf16_f32 v31, v124, -v125
    v_lshlrev_b32 v18, 16, v31
    v_and_b32 v19, 0xffff0000, v31
    v_sub_f32 v18, v124, v18
    v_sub_f32 v19, -v125, v19
    v_cvt_pk_bf16_f32 v47, v18, v19
    v_pk_mul_f32 v[122:123], v[120:121], v[120:121] op_sel_hi:[0,1]
    v_pk_fma_f32 v[122:123], v[120:121], v[120:121], v[122:123] op_sel:[1,1,0] op_sel_hi:[0,1,1] neg_lo:[1,0,0]
    v_pk_mul_f32 v[124:125], v[114:115], v[122:123] op_sel_hi:[0,1]
    v_pk_fma_f32 v[124:125], v[114:115], v[122:123], v[124:125] op_sel:[1,1,0] op_sel_hi:[1,0,1] neg_lo:[1,0,0]
    v_cvt_pk_bf16_f32 v35, v124, -v125
    v_lshlrev_b32 v18, 16, v35
    v_and_b32 v19, 0xffff0000, v35
    v_sub_f32 v18, v124, v18
    v_sub_f32 v19, -v125, v19
    v_cvt_pk_bf16_f32 v51, v18, v19
    v_pk_mul_f32 v[120:121], v[122:123], v[122:123] op_sel_hi:[0,1]
    v_pk_fma_f32 v[120:121], v[122:123], v[122:123], v[120:121] op_sel:[1,1,0] op_sel_hi:[0,1,1] neg_lo:[1,0,0]
    v_pk_mul_f32 v[124:125], v[116:117], v[120:121] op_sel_hi:[0,1]
    v_pk_fma_f32 v[124:125], v[116:117], v[120:121], v[124:125] op_sel:[1,1,0] op_sel_hi:[1,0,1] neg_lo:[1,0,0]
    v_cvt_pk_bf16_f32 v39, v124, -v125
    v_lshlrev_b32 v18, 16, v39
    v_and_b32 v19, 0xffff0000, v39
    v_sub_f32 v18, v124, v18
    v_sub_f32 v19, -v125, v19
    v_cvt_pk_bf16_f32 v55, v18, v19
    s_nop 1
    v_mfma_f32_16x16x32_bf16 v[88:91], v[24:27], v[56:59], v[88:91]
    v_mfma_f32_16x16x32_bf16 v[88:91], v[24:27], v[72:75], v[88:91]
    v_mfma_f32_16x16x32_bf16 v[88:91], v[40:43], v[56:59], v[88:91]
    v_mfma_f32_16x16x32_bf16 v[92:95], v[28:31], v[60:63], v[92:95]
    v_mfma_f32_16x16x32_bf16 v[92:95], v[28:31], v[76:79], v[92:95]
    v_mfma_f32_16x16x32_bf16 v[92:95], v[44:47], v[60:63], v[92:95]
    v_mfma_f32_16x16x32_bf16 v[96:99], v[32:35], v[64:67], v[96:99]
    v_mfma_f32_16x16x32_bf16 v[96:99], v[32:35], v[80:83], v[96:99]
    v_mfma_f32_16x16x32_bf16 v[96:99], v[48:51], v[64:67], v[96:99]
    v_mfma_f32_16x16x32_bf16 v[100:103], v[36:39], v[68:71], v[100:103]
    v_mfma_f32_16x16x32_bf16 v[100:103], v[36:39], v[84:87], v[100:103]
    v_mfma_f32_16x16x32_bf16 v[100:103], v[52:55], v[68:71], v[100:103]
    s_nop 7
    s_nop 1
    s_waitcnt vmcnt(0)
    v_lshlrev_b32 v4, 1, v0
    ds_write_b16 v4, v13 offset:9344
    ds_write_b16_d16_hi v4, v13 offset:45952
    ds_write_b16 v4, v13 offset:13602
    ds_write_b16_d16_hi v4, v13 offset:50210
    ds_write_b16 v4, v13 offset:17860
    ds_write_b16_d16_hi v4, v13 offset:54468
    ds_write_b16 v4, v13 offset:22118
    ds_write_b16_d16_hi v4, v13 offset:58726
    ds_write_b16 v4, v14 offset:10368
    ds_write_b16_d16_hi v4, v14 offset:46976
    ds_write_b16 v4, v14 offset:14626
    ds_write_b16_d16_hi v4, v14 offset:51234
    ds_write_b16 v4, v14 offset:18884
    ds_write_b16_d16_hi v4, v14 offset:55492
    ds_write_b16 v4, v14 offset:23142
    ds_write_b16_d16_hi v4, v14 offset:59750
    ds_write_b16 v4, v15 offset:11392
    ds_write_b16_d16_hi v4, v15 offset:48000
    ds_write_b16 v4, v15 offset:15650
    ds_write_b16_d16_hi v4, v15 offset:52258
    ds_write_b16 v4, v15 offset:19908
    ds_write_b16_d16_hi v4, v15 offset:56516
    ds_write_b16 v4, v15 offset:24166
    ds_write_b16_d16_hi v4, v15 offset:60774
    ds_write_b16 v4, v16 offset:12416
    ds_write_b16_d16_hi v4, v16 offset:49024
    ds_write_b16 v4, v16 offset:16674
    ds_write_b16_d16_hi v4, v16 offset:53282
    ds_write_b16 v4, v16 offset:20932
    ds_write_b16_d16_hi v4, v16 offset:57540
    ds_write_b16 v4, v16 offset:25190
    ds_write_b16_d16_hi v4, v16 offset:61798
    v_lshrrev_b32 v4, 4, v2
    v_lshlrev_b32 v4, 6, v4
    v_and_b32 v5, 15, v2
    v_add_u32 v4, v4, v5
    v_lshlrev_b32 v4, 2, v4
    s_mul_i32 s56, s55, 2592
    s_add_u32 s56, s56, s60
    v_add_u32 v4, s56, v4
    ds_write_b32 v4, v88 offset:26240
    ds_write_b32 v4, v89 offset:26304
    ds_write_b32 v4, v90 offset:26368
    ds_write_b32 v4, v91 offset:26432
    v_cmp_gt_u32 vcc, 33, v2
    s_and_saveexec_b64 s[58:59], vcc
    ds_write_b32 v4, v100 offset:28288
    v_cmp_gt_u32 vcc, 32, v2
    s_and_b64 exec, exec, vcc
    ds_write_b32 v4, v92 offset:27264
    ds_write_b32 v4, v93 offset:27328
    ds_write_b32 v4, v94 offset:27392
    ds_write_b32 v4, v95 offset:27456
    ds_write_b32 v4, v96 offset:27776
    ds_write_b32 v4, v97 offset:27840
    ds_write_b32 v4, v98 offset:27904
    ds_write_b32 v4, v99 offset:27968
    ds_write_b32 v4, v101 offset:28352
    ds_write_b32 v4, v102 offset:28416
    ds_write_b32 v4, v103 offset:28480
    s_mov_b64 exec, s[58:59]
    s_waitcnt lgkmcnt(0)
    s_barrier
    v_mov_b32 v64, 0
    v_mov_b32 v65, 0
    v_mov_b32 v66, 0
    v_mov_b32 v67, 0
    v_lshlrev_b32 v4, 4, v1
    v_add_u32 v4, s60, v4
    ds_write_b128 v4, v[64:67] offset:0
    v_cmp_gt_u32 vcc, 32, v1
    s_and_saveexec_b64 s[58:59], vcc
    ds_write_b128 v4, v[64:67] offset:4096
    s_mov_b64 exec, s[58:59]
    v_lshlrev_b32 v24, 3, v1
    v_or_b32 v4, 1, v24
    v_ffbh_u32 v23, v4
    v_sub_u32 v23, 24, v23
    v_max_i32 v23, 0, v23
    v_lshlrev_b32 v68, v23, 1
    v_lshrrev_b32 v68, 1, v68
    v_min_u32 v69, 1, v23
    v_sub_u32 v68, v68, v69
    v_add_u32 v4, 0, v24
    v_lshrrev_b32 v5, v23, v4
    v_and_b32 v5, v69, v5
    v_add3_u32 v5, v5, v68, v4
    v_lshrrev_b32 v5, v23, v5
    v_lshl_add_u32 v5, v23, 7, v5
    v_lshl_add_u32 v5, v5, 2, s60
    ds_read_b32 v25, v5 offset:26240
    ds_read_b32 v33, v5 offset:28832
    ds_read_b32 v41, v5 offset:31424
    ds_read_b32 v49, v5 offset:34016
    v_add_u32 v4, 1, v24
    v_lshrrev_b32 v5, v23, v4
    v_and_b32 v5, v69, v5
    v_add3_u32 v5, v5, v68, v4
    v_lshrrev_b32 v5, v23, v5
    v_lshl_add_u32 v5, v23, 7, v5
    v_lshl_add_u32 v5, v5, 2, s60
    ds_read_b32 v26, v5 offset:26240
    ds_read_b32 v34, v5 offset:28832
    ds_read_b32 v42, v5 offset:31424
    ds_read_b32 v50, v5 offset:34016
    v_add_u32 v4, 2, v24
    v_lshrrev_b32 v5, v23, v4
    v_and_b32 v5, v69, v5
    v_add3_u32 v5, v5, v68, v4
    v_lshrrev_b32 v5, v23, v5
    v_lshl_add_u32 v5, v23, 7, v5
    v_lshl_add_u32 v5, v5, 2, s60
    ds_read_b32 v27, v5 offset:26240
    ds_read_b32 v35, v5 offset:28832
    ds_read_b32 v43, v5 offset:31424
    ds_read_b32 v51, v5 offset:34016
    v_add_u32 v4, 3, v24
    v_lshrrev_b32 v5, v23, v4
    v_and_b32 v5, v69, v5
    v_add3_u32 v5, v5, v68, v4
    v_lshrrev_b32 v5, v23, v5
    v_lshl_add_u32 v5, v23, 7, v5
    v_lshl_add_u32 v5, v5, 2, s60
    ds_read_b32 v28, v5 offset:26240
    ds_read_b32 v36, v5 offset:28832
    ds_read_b32 v44, v5 offset:31424
    ds_read_b32 v52, v5 offset:34016
    v_add_u32 v4, 4, v24
    v_lshrrev_b32 v5, v23, v4
    v_and_b32 v5, v69, v5
    v_add3_u32 v5, v5, v68, v4
    v_lshrrev_b32 v5, v23, v5
    v_lshl_add_u32 v5, v23, 7, v5
    v_lshl_add_u32 v5, v5, 2, s60
    ds_read_b32 v29, v5 offset:26240
    ds_read_b32 v37, v5 offset:28832
    ds_read_b32 v45, v5 offset:31424
    ds_read_b32 v53, v5 offset:34016
    v_add_u32 v4, 5, v24
    v_lshrrev_b32 v5, v23, v4
    v_and_b32 v5, v69, v5
    v_add3_u32 v5, v5, v68, v4
    v_lshrrev_b32 v5, v23, v5
    v_lshl_add_u32 v5, v23, 7, v5
    v_lshl_add_u32 v5, v5, 2, s60
    ds_read_b32 v30, v5 offset:26240
    ds_read_b32 v38, v5 offset:28832
    ds_read_b32 v46, v5 offset:31424
    ds_read_b32 v54, v5 offset:34016
    v_add_u32 v4, 6, v24
    v_lshrrev_b32 v5, v23, v4
    v_and_b32 v5, v69, v5
    v_add3_u32 v5, v5, v68, v4
    v_lshrrev_b32 v5, v23, v5
    v_lshl_add_u32 v5, v23, 7, v5
    v_lshl_add_u32 v5, v5, 2, s60
    ds_read_b32 v31, v5 offset:26240
    ds_read_b32 v39, v5 offset:28832
    ds_read_b32 v47, v5 offset:31424
    ds_read_b32 v55, v5 offset:34016
    v_add_u32 v4, 7, v24
    v_lshrrev_b32 v5, v23, v4
    v_and_b32 v5, v69, v5
    v_add3_u32 v5, v5, v68, v4
    v_lshrrev_b32 v5, v23, v5
    v_lshl_add_u32 v5, v23, 7, v5
    v_lshl_add_u32 v5, v5, 2, s60
    ds_read_b32 v32, v5 offset:26240
    ds_read_b32 v40, v5 offset:28832
    ds_read_b32 v48, v5 offset:31424
    ds_read_b32 v56, v5 offset:34016
    s_waitcnt lgkmcnt(0)
    v_add_f32 v25, v25, v33
    v_add_f32 v41, v41, v49
    v_add_f32 v26, v26, v34
    v_add_f32 v42, v42, v50
    v_add_f32 v27, v27, v35
    v_add_f32 v43, v43, v51
    v_add_f32 v28, v28, v36
    v_add_f32 v44, v44, v52
    v_add_f32 v29, v29, v37
    v_add_f32 v45, v45, v53
    v_add_f32 v30, v30, v38
    v_add_f32 v46, v46, v54
    v_add_f32 v31, v31, v39
    v_add_f32 v47, v47, v55
    v_add_f32 v32, v32, v40
    v_add_f32 v48, v48, v56
    v_add_f32 v25, v25, v41
    v_add_f32 v26, v26, v42
    v_add_f32 v27, v27, v43
    v_add_f32 v28, v28, v44
    v_add_f32 v29, v29, v45
    v_add_f32 v30, v30, v46
    v_add_f32 v31, v31, v47
    v_add_f32 v32, v32, v48
    v_cvt_pk_bf16_f32 v60, v25, v26
    v_cvt_pk_bf16_f32 v61, v27, v28
    v_cvt_pk_bf16_f32 v62, v29, v30
    v_cvt_pk_bf16_f32 v63, v31, v32
    v_lshrrev_b32 v4, 3, v1
    v_mul_u32_u24 v4, 144, v4
    v_and_b32 v5, 7, v1
    v_lshl_add_u32 v4, v5, 4, v4
    v_add_u32 v4, s60, v4
    ds_write_b128 v4, v[60:63] offset:4608
    s_waitcnt lgkmcnt(0)
    s_barrier
    v_and_b32 v4, 31, v2
    v_add_u32 v4, 25, v4
    v_mul_u32_u24 v23, 144, v4
    v_lshrrev_b32 v4, 5, v2
    v_lshl_add_u32 v23, v4, 4, v23
    s_mul_i32 s56, s55, 1152
    s_sub_u32 s56, s56, s60
    v_sub_u32 v23, v23, s56
    v_lshrrev_b32 v4, 2, v2
    v_and_b32 v4, 3, v4
    v_mul_u32_u24 v24, 4256, v4
    v_lshrrev_b32 v4, 4, v2
    v_and_b32 v4, 1, v4
    v_lshl_add_u32 v24, v4, 5, v24
    v_lshrrev_b32 v4, 5, v2
    v_lshlrev_b32 v4, 4, v4
    v_sub_u32 v24, v24, v4
    v_and_b32 v4, 3, v2
    v_lshl_add_u32 v24, v4, 3, v24
    s_lshl_b32 s56, s55, 10
    s_add_u32 s56, s56, s60
    v_add_u32 v24, s56, v24
    v_mov_b32 v28, 0
    v_mov_b32 v29, 0
    v_mov_b32 v30, 0
    v_mov_b32 v31, 0
    v_mov_b32 v32, 0
    v_mov_b32 v33, 0
    v_mov_b32 v34, 0
    v_mov_b32 v35, 0
    v_mov_b32 v36, 0
    v_mov_b32 v37, 0
    v_mov_b32 v38, 0
    v_mov_b32 v39, 0
    v_mov_b32 v40, 0
    v_mov_b32 v41, 0
    v_mov_b32 v42, 0
    v_mov_b32 v43, 0
    v_mov_b32 v44, 0
    v_mov_b32 v45, 0
    v_mov_b32 v46, 0
    v_mov_b32 v47, 0
    v_mov_b32 v48, 0
    v_mov_b32 v49, 0
    v_mov_b32 v50, 0
    v_mov_b32 v51, 0
    v_mov_b32 v52, 0
    v_mov_b32 v53, 0
    v_mov_b32 v54, 0
    v_mov_b32 v55, 0
    v_mov_b32 v56, 0
    v_mov_b32 v57, 0
    v_mov_b32 v58, 0
    v_mov_b32 v59, 0
    ds_read_b128 v[64:67], v23 offset:1008
    ds_read_b128 v[68:71], v23 offset:1040
    ds_read_b128 v[72:75], v23 offset:1072
    ds_read_b128 v[76:79], v23 offset:1104
    ds_read_b64_tr_b16 v[80:81], v24 offset:9248
    ds_read_b64_tr_b16 v[82:83], v24 offset:9240
    ds_read_b64_tr_b16 v[84:85], v24 offset:9280
    ds_read_b64_tr_b16 v[86:87], v24 offset:9272
    ds_read_b64_tr_b16 v[88:89], v24 offset:9312
    ds_read_b64_tr_b16 v[90:91], v24 offset:9304
    ds_read_b64_tr_b16 v[92:93], v24 offset:9344
    ds_read_b64_tr_b16 v[94:95], v24 offset:9336
    ds_read_b64_tr_b16 v[96:97], v24 offset:9376
    ds_read_b64_tr_b16 v[98:99], v24 offset:9368
    ds_read_b64_tr_b16 v[100:101], v24 offset:9408
    ds_read_b64_tr_b16 v[102:103], v24 offset:9400
    s_waitcnt lgkmcnt(0)
    v_mfma_f32_32x32x16_bf16 v[28:43], v[64:67], v[92:95], v[28:43]
    v_mfma_f32_32x32x16_bf16 v[44:59], v[64:67], v[100:103], v[44:59]
    v_mfma_f32_32x32x16_bf16 v[28:43], v[68:71], v[88:91], v[28:43]
    v_mfma_f32_32x32x16_bf16 v[44:59], v[68:71], v[96:99], v[44:59]
    v_mfma_f32_32x32x16_bf16 v[28:43], v[72:75], v[84:87], v[28:43]
    v_mfma_f32_32x32x16_bf16 v[44:59], v[72:75], v[92:95], v[44:59]
    v_mfma_f32_32x32x16_bf16 v[28:43], v[76:79], v[80:83], v[28:43]
    v_mfma_f32_32x32x16_bf16 v[44:59], v[76:79], v[88:91], v[44:59]
    ds_read_b128 v[64:67], v23 offset:864
    ds_read_b128 v[68:71], v23 offset:896
    ds_read_b128 v[72:75], v23 offset:928
    ds_read_b128 v[76:79], v23 offset:960
    ds_read_b64_tr_b16 v[80:81], v24 offset:9376
    ds_read_b64_tr_b16 v[82:83], v24 offset:9368
    ds_read_b64_tr_b16 v[84:85], v24 offset:9408
    ds_read_b64_tr_b16 v[86:87], v24 offset:9400
    ds_read_b64_tr_b16 v[88:89], v24 offset:9440
    ds_read_b64_tr_b16 v[90:91], v24 offset:9432
    ds_read_b64_tr_b16 v[92:93], v24 offset:9472
    ds_read_b64_tr_b16 v[94:95], v24 offset:9464
    ds_read_b64_tr_b16 v[96:97], v24 offset:9504
    ds_read_b64_tr_b16 v[98:99], v24 offset:9496
    ds_read_b64_tr_b16 v[100:101], v24 offset:9536
    ds_read_b64_tr_b16 v[102:103], v24 offset:9528
    s_waitcnt lgkmcnt(0)
    v_mfma_f32_32x32x16_bf16 v[28:43], v[64:67], v[92:95], v[28:43]
    v_mfma_f32_32x32x16_bf16 v[44:59], v[64:67], v[100:103], v[44:59]
    v_mfma_f32_32x32x16_bf16 v[28:43], v[68:71], v[88:91], v[28:43]
    v_mfma_f32_32x32x16_bf16 v[44:59], v[68:71], v[96:99], v[44:59]
    v_mfma_f32_32x32x16_bf16 v[28:43], v[72:75], v[84:87], v[28:43]
    v_mfma_f32_32x32x16_bf16 v[44:59], v[72:75], v[92:95], v[44:59]
    v_mfma_f32_32x32x16_bf16 v[28:43], v[76:79], v[80:83], v[28:43]
    v_mfma_f32_32x32x16_bf16 v[44:59], v[76:79], v[88:91], v[44:59]
    ds_read_b128 v[64:67], v23 offset:720
    ds_read_b128 v[68:71], v23 offset:752
    ds_read_b128 v[72:75], v23 offset:784
    ds_read_b128 v[76:79], v23 offset:816
    ds_read_b64_tr_b16 v[80:81], v24 offset:9504
    ds_read_b64_tr_b16 v[82:83], v24 offset:9496
    ds_read_b64_tr_b16 v[84:85], v24 offset:9536
    ds_read_b64_tr_b16 v[86:87], v24 offset:9528
    ds_read_b64_tr_b16 v[88:89], v24 offset:9568
    ds_read_b64_tr_b16 v[90:91], v24 offset:9560
    ds_read_b64_tr_b16 v[92:93], v24 offset:9600
    ds_read_b64_tr_b16 v[94:95], v24 offset:9592
    ds_read_b64_tr_b16 v[96:97], v24 offset:9632
    ds_read_b64_tr_b16 v[98:99], v24 offset:9624
    ds_read_b64_tr_b16 v[100:101], v24 offset:9664
    ds_read_b64_tr_b16 v[102:103], v24 offset:9656
    s_waitcnt lgkmcnt(0)
    v_mfma_f32_32x32x16_bf16 v[28:43], v[64:67], v[92:95], v[28:43]
    v_mfma_f32_32x32x16_bf16 v[44:59], v[64:67], v[100:103], v[44:59]
    v_mfma_f32_32x32x16_bf16 v[28:43], v[68:71], v[88:91], v[28:43]
    v_mfma_f32_32x32x16_bf16 v[44:59], v[68:71], v[96:99], v[44:59]
    v_mfma_f32_32x32x16_bf16 v[28:43], v[72:75], v[84:87], v[28:43]
    v_mfma_f32_32x32x16_bf16 v[44:59], v[72:75], v[92:95], v[44:59]
    v_mfma_f32_32x32x16_bf16 v[28:43], v[76:79], v[80:83], v[28:43]
    v_mfma_f32_32x32x16_bf16 v[44:59], v[76:79], v[88:91], v[44:59]
    ds_read_b128 v[64:67], v23 offset:576
    ds_read_b128 v[68:71], v23 offset:608
    ds_read_b128 v[72:75], v23 offset:640
    ds_read_b128 v[76:79], v23 offset:672
    ds_read_b64_tr_b16 v[80:81], v24 offset:9632
    ds_read_b64_tr_b16 v[82:83], v24 offset:9624
    ds_read_b64_tr_b16 v[84:85], v24 offset:9664
    ds_read_b64_tr_b16 v[86:87], v24 offset:9656
    ds_read_b64_tr_b16 v[88:89], v24 offset:9696
    ds_read_b64_tr_b16 v[90:91], v24 offset:9688
    ds_read_b64_tr_b16 v[92:93], v24 offset:9728
    ds_read_b64_tr_b16 v[94:95], v24 offset:9720
    ds_read_b64_tr_b16 v[96:97], v24 offset:9760
    ds_read_b64_tr_b16 v[98:99], v24 offset:9752
    ds_read_b64_tr_b16 v[100:101], v24 offset:9792
    ds_read_b64_tr_b16 v[102:103], v24 offset:9784
    s_waitcnt lgkmcnt(0)
    v_mfma_f32_32x32x16_bf16 v[28:43], v[64:67], v[92:95], v[28:43]
    v_mfma_f32_32x32x16_bf16 v[44:59], v[64:67], v[100:103], v[44:59]
    v_mfma_f32_32x32x16_bf16 v[28:43], v[68:71], v[88:91], v[28:43]
    v_mfma_f32_32x32x16_bf16 v[44:59], v[68:71], v[96:99], v[44:59]
    v_mfma_f32_32x32x16_bf16 v[28:43], v[72:75], v[84:87], v[28:43]
    v_mfma_f32_32x32x16_bf16 v[44:59], v[72:75], v[92:95], v[44:59]
    v_mfma_f32_32x32x16_bf16 v[28:43], v[76:79], v[80:83], v[28:43]
    v_mfma_f32_32x32x16_bf16 v[44:59], v[76:79], v[88:91], v[44:59]
    ds_read_b128 v[64:67], v23 offset:432
    ds_read_b128 v[68:71], v23 offset:464
    ds_read_b128 v[72:75], v23 offset:496
    ds_read_b128 v[76:79], v23 offset:528
    ds_read_b64_tr_b16 v[80:81], v24 offset:9760
    ds_read_b64_tr_b16 v[82:83], v24 offset:9752
    ds_read_b64_tr_b16 v[84:85], v24 offset:9792
    ds_read_b64_tr_b16 v[86:87], v24 offset:9784
    ds_read_b64_tr_b16 v[88:89], v24 offset:9824
    ds_read_b64_tr_b16 v[90:91], v24 offset:9816
    ds_read_b64_tr_b16 v[92:93], v24 offset:9856
    ds_read_b64_tr_b16 v[94:95], v24 offset:9848
    ds_read_b64_tr_b16 v[96:97], v24 offset:9888
    ds_read_b64_tr_b16 v[98:99], v24 offset:9880
    ds_read_b64_tr_b16 v[100:101], v24 offset:9920
    ds_read_b64_tr_b16 v[102:103], v24 offset:9912
    s_waitcnt lgkmcnt(0)
    v_mfma_f32_32x32x16_bf16 v[28:43], v[64:67], v[92:95], v[28:43]
    v_mfma_f32_32x32x16_bf16 v[44:59], v[64:67], v[100:103], v[44:59]
    v_mfma_f32_32x32x16_bf16 v[28:43], v[68:71], v[88:91], v[28:43]
    v_mfma_f32_32x32x16_bf16 v[44:59], v[68:71], v[96:99], v[44:59]
    v_mfma_f32_32x32x16_bf16 v[28:43], v[72:75], v[84:87], v[28:43]
    v_mfma_f32_32x32x16_bf16 v[44:59], v[72:75], v[92:95], v[44:59]
    v_mfma_f32_32x32x16_bf16 v[28:43], v[76:79], v[80:83], v[28:43]
    v_mfma_f32_32x32x16_bf16 v[44:59], v[76:79], v[88:91], v[44:59]
    ds_read_b128 v[64:67], v23 offset:288
    ds_read_b128 v[68:71], v23 offset:320
    ds_read_b128 v[72:75], v23 offset:352
    ds_read_b128 v[76:79], v23 offset:384
    ds_read_b64_tr_b16 v[80:81], v24 offset:9888
    ds_read_b64_tr_b16 v[82:83], v24 offset:9880
    ds_read_b64_tr_b16 v[84:85], v24 offset:9920
    ds_read_b64_tr_b16 v[86:87], v24 offset:9912
    ds_read_b64_tr_b16 v[88:89], v24 offset:9952
    ds_read_b64_tr_b16 v[90:91], v24 offset:9944
    ds_read_b64_tr_b16 v[92:93], v24 offset:9984
    ds_read_b64_tr_b16 v[94:95], v24 offset:9976
    ds_read_b64_tr_b16 v[96:97], v24 offset:10016
    ds_read_b64_tr_b16 v[98:99], v24 offset:10008
    ds_read_b64_tr_b16 v[100:101], v24 offset:10048
    ds_read_b64_tr_b16 v[102:103], v24 offset:10040
    s_waitcnt lgkmcnt(0)
    v_mfma_f32_32x32x16_bf16 v[28:43], v[64:67], v[92:95], v[28:43]
    v_mfma_f32_32x32x16_bf16 v[44:59], v[64:67], v[100:103], v[44:59]
    v_mfma_f32_32x32x16_bf16 v[28:43], v[68:71], v[88:91], v[28:43]
    v_mfma_f32_32x32x16_bf16 v[44:59], v[68:71], v[96:99], v[44:59]
    v_mfma_f32_32x32x16_bf16 v[28:43], v[72:75], v[84:87], v[28:43]
    v_mfma_f32_32x32x16_bf16 v[44:59], v[72:75], v[92:95], v[44:59]
    v_mfma_f32_32x32x16_bf16 v[28:43], v[76:79], v[80:83], v[28:43]
    v_mfma_f32_32x32x16_bf16 v[44:59], v[76:79], v[88:91], v[44:59]
    ds_read_b128 v[64:67], v23 offset:144
    ds_read_b128 v[68:71], v23 offset:176
    ds_read_b128 v[72:75], v23 offset:208
    ds_read_b128 v[76:79], v23 offset:240
    ds_read_b64_tr_b16 v[80:81], v24 offset:10016
    ds_read_b64_tr_b16 v[82:83], v24 offset:10008
    ds_read_b64_tr_b16 v[84:85], v24 offset:10048
    ds_read_b64_tr_b16 v[86:87], v24 offset:10040
    ds_read_b64_tr_b16 v[88:89], v24 offset:10080
    ds_read_b64_tr_b16 v[90:91], v24 offset:10072
    ds_read_b64_tr_b16 v[92:93], v24 offset:10112
    ds_read_b64_tr_b16 v[94:95], v24 offset:10104
    ds_read_b64_tr_b16 v[96:97], v24 offset:10144
    ds_read_b64_tr_b16 v[98:99], v24 offset:10136
    ds_read_b64_tr_b16 v[100:101], v24 offset:10176
    ds_read_b64_tr_b16 v[102:103], v24 offset:10168
    s_waitcnt lgkmcnt(0)
    v_mfma_f32_32x32x16_bf16 v[28:43], v[64:67], v[92:95], v[28:43]
    v_mfma_f32_32x32x16_bf16 v[44:59], v[64:67], v[100:103], v[44:59]
    v_mfma_f32_32x32x16_bf16 v[28:43], v[68:71], v[88:91], v[28:43]
    v_mfma_f32_32x32x16_bf16 v[44:59], v[68:71], v[96:99], v[44:59]
    v_mfma_f32_32x32x16_bf16 v[28:43], v[72:75], v[84:87], v[28:43]
    v_mfma_f32_32x32x16_bf16 v[44:59], v[72:75], v[92:95], v[44:59]
    v_mfma_f32_32x32x16_bf16 v[28:43], v[76:79], v[80:83], v[28:43]
    v_mfma_f32_32x32x16_bf16 v[44:59], v[76:79], v[88:91], v[44:59]
    ds_read_b128 v[64:67], v23 offset:0
    ds_read_b128 v[68:71], v23 offset:32
    ds_read_b128 v[72:75], v23 offset:64
    ds_read_b128 v[76:79], v23 offset:96
    ds_read_b64_tr_b16 v[80:81], v24 offset:10144
    ds_read_b64_tr_b16 v[82:83], v24 offset:10136
    ds_read_b64_tr_b16 v[84:85], v24 offset:10176
    ds_read_b64_tr_b16 v[86:87], v24 offset:10168
    ds_read_b64_tr_b16 v[88:89], v24 offset:10208
    ds_read_b64_tr_b16 v[90:91], v24 offset:10200
    ds_read_b64_tr_b16 v[92:93], v24 offset:10240
    ds_read_b64_tr_b16 v[94:95], v24 offset:10232
    ds_read_b64_tr_b16 v[96:97], v24 offset:10272
    ds_read_b64_tr_b16 v[98:99], v24 offset:10264
    ds_read_b64_tr_b16 v[100:101], v24 offset:10304
    ds_read_b64_tr_b16 v[102:103], v24 offset:10296
    s_waitcnt lgkmcnt(0)
    v_mfma_f32_32x32x16_bf16 v[28:43], v[64:67], v[92:95], v[28:43]
    v_mfma_f32_32x32x16_bf16 v[44:59], v[64:67], v[100:103], v[44:59]
    v_mfma_f32_32x32x16_bf16 v[28:43], v[68:71], v[88:91], v[28:43]
    v_mfma_f32_32x32x16_bf16 v[44:59], v[68:71], v[96:99], v[44:59]
    v_mfma_f32_32x32x16_bf16 v[28:43], v[72:75], v[84:87], v[28:43]
    v_mfma_f32_32x32x16_bf16 v[44:59], v[72:75], v[92:95], v[44:59]
    v_mfma_f32_32x32x16_bf16 v[28:43], v[76:79], v[80:83], v[28:43]
    v_mfma_f32_32x32x16_bf16 v[44:59], v[76:79], v[88:91], v[44:59]
    s_nop 15
    s_nop 3
    v_lshlrev_b32 v4, 4, v1
    v_add_u32 v4, s60, v4
    ds_read_b128 v[60:63], v4 offset:9344
    s_waitcnt lgkmcnt(0)
    s_barrier
    v_lshrrev_b32 v4, 5, v2
    v_lshlrev_b32 v4, 10, v4
    v_and_b32 v5, 31, v2
    v_lshl_add_u32 v4, v5, 2, v4
    s_lshl_b32 s56, s55, 13
    s_add_u32 s56, s56, s60
    v_add_u32 v4, s56, v4
    ds_write_b32 v4, v28 offset:0
    ds_write_b32 v4, v29 offset:256
    ds_write_b32 v4, v30 offset:512
    ds_write_b32 v4, v31 offset:768
    ds_write_b32 v4, v32 offset:2048
    ds_write_b32 v4, v33 offset:2304
    ds_write_b32 v4, v34 offset:2560
    ds_write_b32 v4, v35 offset:2816
    ds_write_b32 v4, v36 offset:4096
    ds_write_b32 v4, v37 offset:4352
    ds_write_b32 v4, v38 offset:4608
    ds_write_b32 v4, v39 offset:4864
    ds_write_b32 v4, v40 offset:6144
    ds_write_b32 v4, v41 offset:6400
    ds_write_b32 v4, v42 offset:6656
    ds_write_b32 v4, v43 offset:6912
    ds_write_b32 v4, v44 offset:128
    ds_write_b32 v4, v45 offset:384
    ds_write_b32 v4, v46 offset:640
    ds_write_b32 v4, v47 offset:896
    ds_write_b32 v4, v48 offset:2176
    ds_write_b32 v4, v49 offset:2432
    ds_write_b32 v4, v50 offset:2688
    ds_write_b32 v4, v51 offset:2944
    ds_write_b32 v4, v52 offset:4224
    ds_write_b32 v4, v53 offset:4480
    ds_write_b32 v4, v54 offset:4736
    ds_write_b32 v4, v55 offset:4992
    ds_write_b32 v4, v56 offset:6272
    ds_write_b32 v4, v57 offset:6528
    ds_write_b32 v4, v58 offset:6784
    ds_write_b32 v4, v59 offset:7040
    s_waitcnt lgkmcnt(0)
    s_barrier
    v_lshlrev_b32 v4, 5, v1
    v_add_u32 v4, s60, v4
    ds_read_b128 v[64:67], v4 offset:0
    ds_read_b128 v[68:71], v4 offset:16
    ds_read_b128 v[72:75], v4 offset:8192
    ds_read_b128 v[76:79], v4 offset:8208
    ds_read_b128 v[80:83], v4 offset:16384
    ds_read_b128 v[84:87], v4 offset:16400
    ds_read_b128 v[88:91], v4 offset:24576
    ds_read_b128 v[92:95], v4 offset:24592
    s_waitcnt lgkmcnt(0)
    v_add_f32 v64, v64, v72
    v_add_f32 v80, v80, v88
    v_add_f32 v65, v65, v73
    v_add_f32 v81, v81, v89
    v_add_f32 v66, v66, v74
    v_add_f32 v82, v82, v90
    v_add_f32 v67, v67, v75
    v_add_f32 v83, v83, v91
    v_add_f32 v68, v68, v76
    v_add_f32 v84, v84, v92
    v_add_f32 v69, v69, v77
    v_add_f32 v85, v85, v93
    v_add_f32 v70, v70, v78
    v_add_f32 v86, v86, v94
    v_add_f32 v71, v71, v79
    v_add_f32 v87, v87, v95
    v_add_f32 v64, v64, v80
    v_add_f32 v65, v65, v81
    v_add_f32 v66, v66, v82
    v_add_f32 v67, v67, v83
    v_add_f32 v68, v68, v84
    v_add_f32 v69, v69, v85
    v_add_f32 v70, v70, v86
    v_add_f32 v71, v71, v87
    v_cvt_pk_bf16_f32 v4, v64, v65
    v_lshlrev_b32 v64, 16, v4
    v_and_b32 v65, 0xffff0000, v4
    v_lshlrev_b32 v5, 16, v60
    v_and_b32 v6, 0xffff0000, v60
    v_mul_f32 v5, v12, v5
    v_mul_f32 v6, v12, v6
    v_cvt_pk_bf16_f32 v4, v5, v6
    v_lshlrev_b32 v5, 16, v4
    v_and_b32 v6, 0xffff0000, v4
    v_add_f32 v5, v5, v64
    v_add_f32 v6, v6, v65
    v_cvt_pk_bf16_f32 v96, v5, v6
    v_cvt_pk_bf16_f32 v4, v66, v67
    v_lshlrev_b32 v66, 16, v4
    v_and_b32 v67, 0xffff0000, v4
    v_lshlrev_b32 v5, 16, v61
    v_and_b32 v6, 0xffff0000, v61
    v_mul_f32 v5, v12, v5
    v_mul_f32 v6, v12, v6
    v_cvt_pk_bf16_f32 v4, v5, v6
    v_lshlrev_b32 v5, 16, v4
    v_and_b32 v6, 0xffff0000, v4
    v_add_f32 v5, v5, v66
    v_add_f32 v6, v6, v67
    v_cvt_pk_bf16_f32 v97, v5, v6
    v_cvt_pk_bf16_f32 v4, v68, v69
    v_lshlrev_b32 v68, 16, v4
    v_and_b32 v69, 0xffff0000, v4
    v_lshlrev_b32 v5, 16, v62
    v_and_b32 v6, 0xffff0000, v62
    v_mul_f32 v5, v12, v5
    v_mul_f32 v6, v12, v6
    v_cvt_pk_bf16_f32 v4, v5, v6
    v_lshlrev_b32 v5, 16, v4
    v_and_b32 v6, 0xffff0000, v4
    v_add_f32 v5, v5, v68
    v_add_f32 v6, v6, v69
    v_cvt_pk_bf16_f32 v98, v5, v6
    v_cvt_pk_bf16_f32 v4, v70, v71
    v_lshlrev_b32 v70, 16, v4
    v_and_b32 v71, 0xffff0000, v4
    v_lshlrev_b32 v5, 16, v63
    v_and_b32 v6, 0xffff0000, v63
    v_mul_f32 v5, v12, v5
    v_mul_f32 v6, v12, v6
    v_cvt_pk_bf16_f32 v4, v5, v6
    v_lshlrev_b32 v5, 16, v4
    v_and_b32 v6, 0xffff0000, v4
    v_add_f32 v5, v5, v70
    v_add_f32 v6, v6, v71
    v_cvt_pk_bf16_f32 v99, v5, v6
    v_lshlrev_b32 v4, 4, v1
    s_lshl_b32 s56, s54, 12
    s_add_u32 s56, s56, 0x800000
    buffer_store_dwordx4 v[96:99], v4, s[16:19], s56 offen
    s_endpgm
L_k1_g:
    s_setprio 3
    s_load_dwordx2 s[16:17], s[0:1], 0
    s_load_dwordx2 s[18:19], s[0:1], 64
    s_load_dwordx2 s[20:21], s[0:1], 104
    s_waitcnt lgkmcnt(0)
    s_mov_b32 s4, s16
    s_mov_b32 s5, s17
    s_mov_b32 s6, 0x280000
    s_mov_b32 s7, 0x00020000
    s_mov_b32 s8, s18
    s_mov_b32 s9, s19
    s_mov_b32 s10, 0x21c000
    s_mov_b32 s11, 0x00020000
    s_mov_b32 s12, s20
    s_mov_b32 s13, s21
    s_mov_b32 s14, 0x6c0000
    s_mov_b32 s15, 0x00020000
    s_and_b32 s22, s2, 7
    s_lshr_b32 s23, s2, 3
    s_lshl_b32 s24, s22, 8
    s_lshl_b32 s25, s23, 7
    v_and_b32 v1, 63, v0
    v_lshrrev_b32 v2, 6, v0
    s_nop 0
    v_readfirstlane_b32 s26, v2
    s_nop 4
    s_lshr_b32 s27, s26, 1
    s_and_b32 s28, s26, 1
    s_mul_i32 s29, s26, 128
    s_add_u32 s29, s29, 0
    v_add_u32 v2, s29, v1
    v_lshrrev_b32 v3, 2, v2
    v_and_b32 v2, 3, v2
    v_lshrrev_b32 v4, 2, v3
    v_and_b32 v4, 3, v4
    v_xor_b32 v2, v2, v4
    v_add_u32 v3, s24, v3
    s_mov_b32 s30, 1280
    v_mul_lo_u32 v3, v3, s30
    v_lshl_add_u32 v5, v2, 4, v3
    s_mul_i32 s29, s26, 128
    s_add_u32 s29, s29, 64
    v_add_u32 v2, s29, v1
    v_lshrrev_b32 v3, 2, v2
    v_and_b32 v2, 3, v2
    v_lshrrev_b32 v4, 2, v3
    v_and_b32 v4, 3, v4
    v_xor_b32 v2, v2, v4
    v_add_u32 v3, s24, v3
    s_mov_b32 s30, 1280
    v_mul_lo_u32 v3, v3, s30
    v_lshl_add_u32 v6, v2, 4, v3
    s_mul_i32 s29, s26, 64
    s_add_u32 s29, s29, 0
    v_add_u32 v2, s29, v1
    v_lshrrev_b32 v3, 4, v2
    v_and_b32 v2, 15, v2
    v_and_b32 v4, 3, v3
    v_lshlrev_b32 v4, 2, v4
    v_xor_b32 v2, v2, v4
    s_mov_b32 s30, 3456
    v_mul_lo_u32 v3, v3, s30
    v_lshl_add_u32 v2, v2, 4, v3
    s_lshl_b32 s30, s25, 1
    v_add_u32 v7, s30, v2
    s_mul_i32 s31, s26, 2048
    s_mul_i32 s32, s26, 1024
    v_and_b32 v2, 31, v1
    v_lshrrev_b32 v3, 5, v1
    s_mul_i32 s29, s27, 64
    s_add_u32 s29, s29, 0
    v_add_u32 v4, s29, v2
    v_lshrrev_b32 v12, 2, v4
    v_and_b32 v12, 3, v12
    v_add_u32 v8, 0, v3
    v_xor_b32 v8, v8, v12
    v_lshlrev_b32 v8, 4, v8
    v_lshl_add_u32 v8, v4, 6, v8
    v_add_u32 v9, 2, v3
    v_xor_b32 v9, v9, v12
    v_lshlrev_b32 v9, 4, v9
    v_lshl_add_u32 v9, v4, 6, v9
    s_mul_i32 s29, s27, 64
    s_add_u32 s29, s29, 32
    v_add_u32 v4, s29, v2
    v_lshrrev_b32 v12, 2, v4
    v_and_b32 v12, 3, v12
    v_add_u32 v10, 0, v3
    v_xor_b32 v10, v10, v12
    v_lshlrev_b32 v10, 4, v10
    v_lshl_add_u32 v10, v4, 6, v10
    v_add_u32 v11, 2, v3
    v_xor_b32 v11, v11, v12
    v_lshlrev_b32 v11, 4, v11
    v_lshl_add_u32 v11, v4, 6, v11
    v_lshrrev_b32 v14, 2, v1
    v_and_b32 v14, 3, v14
    v_lshrrev_b32 v15, 5, v1
    v_lshl_add_u32 v15, v15, 3, v14
    v_lshrrev_b32 v2, 4, v1
    v_and_b32 v2, 1, v2
    v_lshlrev_b32 v2, 5, v2
    v_and_b32 v3, 3, v1
    v_lshl_add_u32 v2, v3, 3, v2
    s_mul_i32 s29, s28, 128
    s_add_u32 s29, s29, 0
    v_add_u32 v2, s29, v2
    v_lshlrev_b32 v3, 6, v14
    v_xor_b32 v2, v2, v3
    v_lshl_add_u32 v12, v15, 8, v2
    v_add_u32 v12, 49152, v12
    v_lshrrev_b32 v2, 4, v1
    v_and_b32 v2, 1, v2
    v_lshlrev_b32 v2, 5, v2
    v_and_b32 v3, 3, v1
    v_lshl_add_u32 v2, v3, 3, v2
    s_mul_i32 s29, s28, 128
    s_add_u32 s29, s29, 64
    v_add_u32 v2, s29, v2
    v_lshlrev_b32 v3, 6, v14
    v_xor_b32 v2, v2, v3
    v_lshl_add_u32 v13, v15, 8, v2
    v_add_u32 v13, 49152, v13
    v_mov_b32 v16, 0
    v_mov_b32 v17, 0
    v_mov_b32 v18, 0
    v_mov_b32 v19, 0
    v_mov_b32 v20, 0
    v_mov_b32 v21, 0
    v_mov_b32 v22, 0
    v_mov_b32 v23, 0
    v_mov_b32 v24, 0
    v_mov_b32 v25, 0
    v_mov_b32 v26, 0
    v_mov_b32 v27, 0
    v_mov_b32 v28, 0
    v_mov_b32 v29, 0
    v_mov_b32 v30, 0
    v_mov_b32 v31, 0
    v_mov_b32 v32, 0
    v_mov_b32 v33, 0
    v_mov_b32 v34, 0
    v_mov_b32 v35, 0
    v_mov_b32 v36, 0
    v_mov_b32 v37, 0
    v_mov_b32 v38, 0
    v_mov_b32 v39, 0
    v_mov_b32 v40, 0
    v_mov_b32 v41, 0
    v_mov_b32 v42, 0
    v_mov_b32 v43, 0
    v_mov_b32 v44, 0
    v_mov_b32 v45, 0
    v_mov_b32 v46, 0
    v_mov_b32 v47, 0
    v_mov_b32 v48, 0
    v_mov_b32 v49, 0
    v_mov_b32 v50, 0
    v_mov_b32 v51, 0
    v_mov_b32 v52, 0
    v_mov_b32 v53, 0
    v_mov_b32 v54, 0
    v_mov_b32 v55, 0
    v_mov_b32 v56, 0
    v_mov_b32 v57, 0
    v_mov_b32 v58, 0
    v_mov_b32 v59, 0
    v_mov_b32 v60, 0
    v_mov_b32 v61, 0
    v_mov_b32 v62, 0
    v_mov_b32 v63, 0
    v_mov_b32 v64, 0
    v_mov_b32 v65, 0
    v_mov_b32 v66, 0
    v_mov_b32 v67, 0
    v_mov_b32 v68, 0
    v_mov_b32 v69, 0
    v_mov_b32 v70, 0
    v_mov_b32 v71, 0
    v_mov_b32 v72, 0
    v_mov_b32 v73, 0
    v_mov_b32 v74, 0
    v_mov_b32 v75, 0
    v_mov_b32 v76, 0
    v_mov_b32 v77, 0
    v_mov_b32 v78, 0
    v_mov_b32 v79, 0
    s_mov_b32 s33, 0
    s_mov_b32 s34, 0
    s_add_u32 m0, s31, 0
    s_nop 0
    buffer_load_dwordx4 v5, s[4:7], s33 offen lds
    s_add_u32 m0, s31, 1024
    s_nop 0
    buffer_load_dwordx4 v6, s[4:7], s33 offen lds
    s_add_u32 m0, s32, 49152
    s_nop 0
    buffer_load_dwordx4 v7, s[8:11], s34 offen lds
    s_mov_b32 s33, 64
    s_mov_b32 s34, 110592
    s_add_u32 m0, s31, 16384
    s_nop 0
    buffer_load_dwordx4 v5, s[4:7], s33 offen lds
    s_add_u32 m0, s31, 17408
    s_nop 0
    buffer_load_dwordx4 v6, s[4:7], s33 offen lds
    s_add_u32 m0, s32, 57344
    s_nop 0
    buffer_load_dwordx4 v7, s[8:11], s34 offen lds
    s_waitcnt vmcnt(3)
    s_barrier
    s_mov_b32 s33, 128
    s_mov_b32 s34, 221184
    s_add_u32 m0, s31, 32768
    s_nop 0
    buffer_load_dwordx4 v5, s[4:7], s33 offen lds
    s_add_u32 m0, s31, 33792
    s_nop 0
    buffer_load_dwordx4 v6, s[4:7], s33 offen lds
    s_add_u32 m0, s32, 65536
    s_nop 0
    buffer_load_dwordx4 v7, s[8:11], s34 offen lds
    ds_read_b128 v[80:83], v8 offset:0
    ds_read_b128 v[84:87], v10 offset:0
    ds_read_b64_tr_b16 v[96:97], v12 offset:0
    ds_read_b64_tr_b16 v[98:99], v12 offset:1024
    ds_read_b64_tr_b16 v[100:101], v13 offset:0
    ds_read_b64_tr_b16 v[102:103], v13 offset:1024
    ds_read_b128 v[88:91], v9 offset:0
    ds_read_b128 v[92:95], v11 offset:0
    ds_read_b64_tr_b16 v[104:105], v12 offset:4096
    ds_read_b64_tr_b16 v[106:107], v12 offset:5120
    ds_read_b64_tr_b16 v[108:109], v13 offset:4096
    ds_read_b64_tr_b16 v[110:111], v13 offset:5120
    s_waitcnt lgkmcnt(6)
    v_mfma_f32_32x32x16_bf16 v[16:31], v[96:99], v[80:83], v[16:31]
    v_mfma_f32_32x32x16_bf16 v[32:47], v[96:99], v[84:87], v[32:47]
    v_mfma_f32_32x32x16_bf16 v[48:63], v[100:103], v[80:83], v[48:63]
    v_mfma_f32_32x32x16_bf16 v[64:79], v[100:103], v[84:87], v[64:79]
    s_waitcnt lgkmcnt(0)
    v_mfma_f32_32x32x16_bf16 v[16:31], v[104:107], v[88:91], v[16:31]
    v_mfma_f32_32x32x16_bf16 v[32:47], v[104:107], v[92:95], v[32:47]
    v_mfma_f32_32x32x16_bf16 v[48:63], v[108:111], v[88:91], v[48:63]
    v_mfma_f32_32x32x16_bf16 v[64:79], v[108:111], v[92:95], v[64:79]
    s_waitcnt vmcnt(3)
    s_barrier
    s_mov_b32 s33, 192
    s_mov_b32 s34, 331776
    s_add_u32 m0, s31, 0
    s_nop 0
    buffer_load_dwordx4 v5, s[4:7], s33 offen lds
    s_add_u32 m0, s31, 1024
    s_nop 0
    buffer_load_dwordx4 v6, s[4:7], s33 offen lds
    s_add_u32 m0, s32, 49152
    s_nop 0
    buffer_load_dwordx4 v7, s[8:11], s34 offen lds
    ds_read_b128 v[80:83], v8 offset:16384
    ds_read_b128 v[84:87], v10 offset:16384
    ds_read_b64_tr_b16 v[96:97], v12 offset:8192
    ds_read_b64_tr_b16 v[98:99], v12 offset:9216
    ds_read_b64_tr_b16 v[100:101], v13 offset:8192
    ds_read_b64_tr_b16 v[102:103], v13 offset:9216
    ds_read_b128 v[88:91], v9 offset:16384
    ds_read_b128 v[92:95], v11 offset:16384
    ds_read_b64_tr_b16 v[104:105], v12 offset:12288
    ds_read_b64_tr_b16 v[106:107], v12 offset:13312
    ds_read_b64_tr_b16 v[108:109], v13 offset:12288
    ds_read_b64_tr_b16 v[110:111], v13 offset:13312
    s_waitcnt lgkmcnt(6)
    v_mfma_f32_32x32x16_bf16 v[16:31], v[96:99], v[80:83], v[16:31]
    v_mfma_f32_32x32x16_bf16 v[32:47], v[96:99], v[84:87], v[32:47]
    v_mfma_f32_32x32x16_bf16 v[48:63], v[100:103], v[80:83], v[48:63]
    v_mfma_f32_32x32x16_bf16 v[64:79], v[100:103], v[84:87], v[64:79]
    s_waitcnt lgkmcnt(0)
    v_mfma_f32_32x32x16_bf16 v[16:31], v[104:107], v[88:91], v[16:31]
    v_mfma_f32_32x32x16_bf16 v[32:47], v[104:107], v[92:95], v[32:47]
    v_mfma_f32_32x32x16_bf16 v[48:63], v[108:111], v[88:91], v[48:63]
    v_mfma_f32_32x32x16_bf16 v[64:79], v[108:111], v[92:95], v[64:79]
    s_waitcnt vmcnt(3)
    s_barrier
    s_mov_b32 s33, 256
    s_mov_b32 s34, 442368
    s_add_u32 m0, s31, 16384
    s_nop 0
    buffer_load_dwordx4 v5, s[4:7], s33 offen lds
    s_add_u32 m0, s31, 17408
    s_nop 0
    buffer_load_dwordx4 v6, s[4:7], s33 offen lds
    s_add_u32 m0, s32, 57344
    s_nop 0
    buffer_load_dwordx4 v7, s[8:11], s34 offen lds
    ds_read_b128 v[80:83], v8 offset:32768
    ds_read_b128 v[84:87], v10 offset:32768
    ds_read_b64_tr_b16 v[96:97], v12 offset:16384
    ds_read_b64_tr_b16 v[98:99], v12 offset:17408
    ds_read_b64_tr_b16 v[100:101], v13 offset:16384
    ds_read_b64_tr_b16 v[102:103], v13 offset:17408
    ds_read_b128 v[88:91], v9 offset:32768
    ds_read_b128 v[92:95], v11 offset:32768
    ds_read_b64_tr_b16 v[104:105], v12 offset:20480
    ds_read_b64_tr_b16 v[106:107], v12 offset:21504
    ds_read_b64_tr_b16 v[108:109], v13 offset:20480
    ds_read_b64_tr_b16 v[110:111], v13 offset:21504
    s_waitcnt lgkmcnt(6)
    v_mfma_f32_32x32x16_bf16 v[16:31], v[96:99], v[80:83], v[16:31]
    v_mfma_f32_32x32x16_bf16 v[32:47], v[96:99], v[84:87], v[32:47]
    v_mfma_f32_32x32x16_bf16 v[48:63], v[100:103], v[80:83], v[48:63]
    v_mfma_f32_32x32x16_bf16 v[64:79], v[100:103], v[84:87], v[64:79]
    s_waitcnt lgkmcnt(0)
    v_mfma_f32_32x32x16_bf16 v[16:31], v[104:107], v[88:91], v[16:31]
    v_mfma_f32_32x32x16_bf16 v[32:47], v[104:107], v[92:95], v[32:47]
    v_mfma_f32_32x32x16_bf16 v[48:63], v[108:111], v[88:91], v[48:63]
    v_mfma_f32_32x32x16_bf16 v[64:79], v[108:111], v[92:95], v[64:79]
    s_waitcnt vmcnt(3)
    s_barrier
    s_mov_b32 s33, 320
    s_mov_b32 s34, 552960
    s_add_u32 m0, s31, 32768
    s_nop 0
    buffer_load_dwordx4 v5, s[4:7], s33 offen lds
    s_add_u32 m0, s31, 33792
    s_nop 0
    buffer_load_dwordx4 v6, s[4:7], s33 offen lds
    s_add_u32 m0, s32, 65536
    s_nop 0
    buffer_load_dwordx4 v7, s[8:11], s34 offen lds
    ds_read_b128 v[80:83], v8 offset:0
    ds_read_b128 v[84:87], v10 offset:0
    ds_read_b64_tr_b16 v[96:97], v12 offset:0
    ds_read_b64_tr_b16 v[98:99], v12 offset:1024
    ds_read_b64_tr_b16 v[100:101], v13 offset:0
    ds_read_b64_tr_b16 v[102:103], v13 offset:1024
    ds_read_b128 v[88:91], v9 offset:0
    ds_read_b128 v[92:95], v11 offset:0
    ds_read_b64_tr_b16 v[104:105], v12 offset:4096
    ds_read_b64_tr_b16 v[106:107], v12 offset:5120
    ds_read_b64_tr_b16 v[108:109], v13 offset:4096
    ds_read_b64_tr_b16 v[110:111], v13 offset:5120
    s_waitcnt lgkmcnt(6)
    v_mfma_f32_32x32x16_bf16 v[16:31], v[96:99], v[80:83], v[16:31]
    v_mfma_f32_32x32x16_bf16 v[32:47], v[96:99], v[84:87], v[32:47]
    v_mfma_f32_32x32x16_bf16 v[48:63], v[100:103], v[80:83], v[48:63]
    v_mfma_f32_32x32x16_bf16 v[64:79], v[100:103], v[84:87], v[64:79]
    s_waitcnt lgkmcnt(0)
    v_mfma_f32_32x32x16_bf16 v[16:31], v[104:107], v[88:91], v[16:31]
    v_mfma_f32_32x32x16_bf16 v[32:47], v[104:107], v[92:95], v[32:47]
    v_mfma_f32_32x32x16_bf16 v[48:63], v[108:111], v[88:91], v[48:63]
    v_mfma_f32_32x32x16_bf16 v[64:79], v[108:111], v[92:95], v[64:79]
    s_waitcnt vmcnt(3)
    s_barrier
    s_mov_b32 s33, 384
    s_mov_b32 s34, 663552
    s_add_u32 m0, s31, 0
    s_nop 0
    buffer_load_dwordx4 v5, s[4:7], s33 offen lds
    s_add_u32 m0, s31, 1024
    s_nop 0
    buffer_load_dwordx4 v6, s[4:7], s33 offen lds
    s_add_u32 m0, s32, 49152
    s_nop 0
    buffer_load_dwordx4 v7, s[8:11], s34 offen lds
    ds_read_b128 v[80:83], v8 offset:16384
    ds_read_b128 v[84:87], v10 offset:16384
    ds_read_b64_tr_b16 v[96:97], v12 offset:8192
    ds_read_b64_tr_b16 v[98:99], v12 offset:9216
    ds_read_b64_tr_b16 v[100:101], v13 offset:8192
    ds_read_b64_tr_b16 v[102:103], v13 offset:9216
    ds_read_b128 v[88:91], v9 offset:16384
    ds_read_b128 v[92:95], v11 offset:16384
    ds_read_b64_tr_b16 v[104:105], v12 offset:12288
    ds_read_b64_tr_b16 v[106:107], v12 offset:13312
    ds_read_b64_tr_b16 v[108:109], v13 offset:12288
    ds_read_b64_tr_b16 v[110:111], v13 offset:13312
    s_waitcnt lgkmcnt(6)
    v_mfma_f32_32x32x16_bf16 v[16:31], v[96:99], v[80:83], v[16:31]
    v_mfma_f32_32x32x16_bf16 v[32:47], v[96:99], v[84:87], v[32:47]
    v_mfma_f32_32x32x16_bf16 v[48:63], v[100:103], v[80:83], v[48:63]
    v_mfma_f32_32x32x16_bf16 v[64:79], v[100:103], v[84:87], v[64:79]
    s_waitcnt lgkmcnt(0)
    v_mfma_f32_32x32x16_bf16 v[16:31], v[104:107], v[88:91], v[16:31]
    v_mfma_f32_32x32x16_bf16 v[32:47], v[104:107], v[92:95], v[32:47]
    v_mfma_f32_32x32x16_bf16 v[48:63], v[108:111], v[88:91], v[48:63]
    v_mfma_f32_32x32x16_bf16 v[64:79], v[108:111], v[92:95], v[64:79]
    s_waitcnt vmcnt(3)
    s_barrier
    s_mov_b32 s33, 448
    s_mov_b32 s34, 774144
    s_add_u32 m0, s31, 16384
    s_nop 0
    buffer_load_dwordx4 v5, s[4:7], s33 offen lds
    s_add_u32 m0, s31, 17408
    s_nop 0
    buffer_load_dwordx4 v6, s[4:7], s33 offen lds
    s_add_u32 m0, s32, 57344
    s_nop 0
    buffer_load_dwordx4 v7, s[8:11], s34 offen lds
    ds_read_b128 v[80:83], v8 offset:32768
    ds_read_b128 v[84:87], v10 offset:32768
    ds_read_b64_tr_b16 v[96:97], v12 offset:16384
    ds_read_b64_tr_b16 v[98:99], v12 offset:17408
    ds_read_b64_tr_b16 v[100:101], v13 offset:16384
    ds_read_b64_tr_b16 v[102:103], v13 offset:17408
    ds_read_b128 v[88:91], v9 offset:32768
    ds_read_b128 v[92:95], v11 offset:32768
    ds_read_b64_tr_b16 v[104:105], v12 offset:20480
    ds_read_b64_tr_b16 v[106:107], v12 offset:21504
    ds_read_b64_tr_b16 v[108:109], v13 offset:20480
    ds_read_b64_tr_b16 v[110:111], v13 offset:21504
    s_waitcnt lgkmcnt(6)
    v_mfma_f32_32x32x16_bf16 v[16:31], v[96:99], v[80:83], v[16:31]
    v_mfma_f32_32x32x16_bf16 v[32:47], v[96:99], v[84:87], v[32:47]
    v_mfma_f32_32x32x16_bf16 v[48:63], v[100:103], v[80:83], v[48:63]
    v_mfma_f32_32x32x16_bf16 v[64:79], v[100:103], v[84:87], v[64:79]
    s_waitcnt lgkmcnt(0)
    v_mfma_f32_32x32x16_bf16 v[16:31], v[104:107], v[88:91], v[16:31]
    v_mfma_f32_32x32x16_bf16 v[32:47], v[104:107], v[92:95], v[32:47]
    v_mfma_f32_32x32x16_bf16 v[48:63], v[108:111], v[88:91], v[48:63]
    v_mfma_f32_32x32x16_bf16 v[64:79], v[108:111], v[92:95], v[64:79]
    s_waitcnt vmcnt(3)
    s_barrier
    s_mov_b32 s33, 512
    s_mov_b32 s34, 884736
    s_add_u32 m0, s31, 32768
    s_nop 0
    buffer_load_dwordx4 v5, s[4:7], s33 offen lds
    s_add_u32 m0, s31, 33792
    s_nop 0
    buffer_load_dwordx4 v6, s[4:7], s33 offen lds
    s_add_u32 m0, s32, 65536
    s_nop 0
    buffer_load_dwordx4 v7, s[8:11], s34 offen lds
    ds_read_b128 v[80:83], v8 offset:0
    ds_read_b128 v[84:87], v10 offset:0
    ds_read_b64_tr_b16 v[96:97], v12 offset:0
    ds_read_b64_tr_b16 v[98:99], v12 offset:1024
    ds_read_b64_tr_b16 v[100:101], v13 offset:0
    ds_read_b64_tr_b16 v[102:103], v13 offset:1024
    ds_read_b128 v[88:91], v9 offset:0
    ds_read_b128 v[92:95], v11 offset:0
    ds_read_b64_tr_b16 v[104:105], v12 offset:4096
    ds_read_b64_tr_b16 v[106:107], v12 offset:5120
    ds_read_b64_tr_b16 v[108:109], v13 offset:4096
    ds_read_b64_tr_b16 v[110:111], v13 offset:5120
    s_waitcnt lgkmcnt(6)
    v_mfma_f32_32x32x16_bf16 v[16:31], v[96:99], v[80:83], v[16:31]
    v_mfma_f32_32x32x16_bf16 v[32:47], v[96:99], v[84:87], v[32:47]
    v_mfma_f32_32x32x16_bf16 v[48:63], v[100:103], v[80:83], v[48:63]
    v_mfma_f32_32x32x16_bf16 v[64:79], v[100:103], v[84:87], v[64:79]
    s_waitcnt lgkmcnt(0)
    v_mfma_f32_32x32x16_bf16 v[16:31], v[104:107], v[88:91], v[16:31]
    v_mfma_f32_32x32x16_bf16 v[32:47], v[104:107], v[92:95], v[32:47]
    v_mfma_f32_32x32x16_bf16 v[48:63], v[108:111], v[88:91], v[48:63]
    v_mfma_f32_32x32x16_bf16 v[64:79], v[108:111], v[92:95], v[64:79]
    s_waitcnt vmcnt(3)
    s_barrier
    s_mov_b32 s33, 576
    s_mov_b32 s34, 995328
    s_add_u32 m0, s31, 0
    s_nop 0
    buffer_load_dwordx4 v5, s[4:7], s33 offen lds
    s_add_u32 m0, s31, 1024
    s_nop 0
    buffer_load_dwordx4 v6, s[4:7], s33 offen lds
    s_add_u32 m0, s32, 49152
    s_nop 0
    buffer_load_dwordx4 v7, s[8:11], s34 offen lds
    ds_read_b128 v[80:83], v8 offset:16384
    ds_read_b128 v[84:87], v10 offset:16384
    ds_read_b64_tr_b16 v[96:97], v12 offset:8192
    ds_read_b64_tr_b16 v[98:99], v12 offset:9216
    ds_read_b64_tr_b16 v[100:101], v13 offset:8192
    ds_read_b64_tr_b16 v[102:103], v13 offset:9216
    ds_read_b128 v[88:91], v9 offset:16384
    ds_read_b128 v[92:95], v11 offset:16384
    ds_read_b64_tr_b16 v[104:105], v12 offset:12288
    ds_read_b64_tr_b16 v[106:107], v12 offset:13312
    ds_read_b64_tr_b16 v[108:109], v13 offset:12288
    ds_read_b64_tr_b16 v[110:111], v13 offset:13312
    s_waitcnt lgkmcnt(6)
    v_mfma_f32_32x32x16_bf16 v[16:31], v[96:99], v[80:83], v[16:31]
    v_mfma_f32_32x32x16_bf16 v[32:47], v[96:99], v[84:87], v[32:47]
    v_mfma_f32_32x32x16_bf16 v[48:63], v[100:103], v[80:83], v[48:63]
    v_mfma_f32_32x32x16_bf16 v[64:79], v[100:103], v[84:87], v[64:79]
    s_waitcnt lgkmcnt(0)
    v_mfma_f32_32x32x16_bf16 v[16:31], v[104:107], v[88:91], v[16:31]
    v_mfma_f32_32x32x16_bf16 v[32:47], v[104:107], v[92:95], v[32:47]
    v_mfma_f32_32x32x16_bf16 v[48:63], v[108:111], v[88:91], v[48:63]
    v_mfma_f32_32x32x16_bf16 v[64:79], v[108:111], v[92:95], v[64:79]
    s_waitcnt vmcnt(3)
    s_barrier
    s_mov_b32 s33, 640
    s_mov_b32 s34, 1105920
    s_add_u32 m0, s31, 16384
    s_nop 0
    buffer_load_dwordx4 v5, s[4:7], s33 offen lds
    s_add_u32 m0, s31, 17408
    s_nop 0
    buffer_load_dwordx4 v6, s[4:7], s33 offen lds
    s_add_u32 m0, s32, 57344
    s_nop 0
    buffer_load_dwordx4 v7, s[8:11], s34 offen lds
    ds_read_b128 v[80:83], v8 offset:32768
    ds_read_b128 v[84:87], v10 offset:32768
    ds_read_b64_tr_b16 v[96:97], v12 offset:16384
    ds_read_b64_tr_b16 v[98:99], v12 offset:17408
    ds_read_b64_tr_b16 v[100:101], v13 offset:16384
    ds_read_b64_tr_b16 v[102:103], v13 offset:17408
    ds_read_b128 v[88:91], v9 offset:32768
    ds_read_b128 v[92:95], v11 offset:32768
    ds_read_b64_tr_b16 v[104:105], v12 offset:20480
    ds_read_b64_tr_b16 v[106:107], v12 offset:21504
    ds_read_b64_tr_b16 v[108:109], v13 offset:20480
    ds_read_b64_tr_b16 v[110:111], v13 offset:21504
    s_waitcnt lgkmcnt(6)
    v_mfma_f32_32x32x16_bf16 v[16:31], v[96:99], v[80:83], v[16:31]
    v_mfma_f32_32x32x16_bf16 v[32:47], v[96:99], v[84:87], v[32:47]
    v_mfma_f32_32x32x16_bf16 v[48:63], v[100:103], v[80:83], v[48:63]
    v_mfma_f32_32x32x16_bf16 v[64:79], v[100:103], v[84:87], v[64:79]
    s_waitcnt lgkmcnt(0)
    v_mfma_f32_32x32x16_bf16 v[16:31], v[104:107], v[88:91], v[16:31]
    v_mfma_f32_32x32x16_bf16 v[32:47], v[104:107], v[92:95], v[32:47]
    v_mfma_f32_32x32x16_bf16 v[48:63], v[108:111], v[88:91], v[48:63]
    v_mfma_f32_32x32x16_bf16 v[64:79], v[108:111], v[92:95], v[64:79]
    s_waitcnt vmcnt(3)
    s_barrier
    s_mov_b32 s33, 704
    s_mov_b32 s34, 1216512
    s_add_u32 m0, s31, 32768
    s_nop 0
    buffer_load_dwordx4 v5, s[4:7], s33 offen lds
    s_add_u32 m0, s31, 33792
    s_nop 0
    buffer_load_dwordx4 v6, s[4:7], s33 offen lds
    s_add_u32 m0, s32, 65536
    s_nop 0
    buffer_load_dwordx4 v7, s[8:11], s34 offen lds
    ds_read_b128 v[80:83], v8 offset:0
    ds_read_b128 v[84:87], v10 offset:0
    ds_read_b64_tr_b16 v[96:97], v12 offset:0
    ds_read_b64_tr_b16 v[98:99], v12 offset:1024
    ds_read_b64_tr_b16 v[100:101], v13 offset:0
    ds_read_b64_tr_b16 v[102:103], v13 offset:1024
    ds_read_b128 v[88:91], v9 offset:0
    ds_read_b128 v[92:95], v11 offset:0
    ds_read_b64_tr_b16 v[104:105], v12 offset:4096
    ds_read_b64_tr_b16 v[106:107], v12 offset:5120
    ds_read_b64_tr_b16 v[108:109], v13 offset:4096
    ds_read_b64_tr_b16 v[110:111], v13 offset:5120
    s_waitcnt lgkmcnt(6)
    v_mfma_f32_32x32x16_bf16 v[16:31], v[96:99], v[80:83], v[16:31]
    v_mfma_f32_32x32x16_bf16 v[32:47], v[96:99], v[84:87], v[32:47]
    v_mfma_f32_32x32x16_bf16 v[48:63], v[100:103], v[80:83], v[48:63]
    v_mfma_f32_32x32x16_bf16 v[64:79], v[100:103], v[84:87], v[64:79]
    s_waitcnt lgkmcnt(0)
    v_mfma_f32_32x32x16_bf16 v[16:31], v[104:107], v[88:91], v[16:31]
    v_mfma_f32_32x32x16_bf16 v[32:47], v[104:107], v[92:95], v[32:47]
    v_mfma_f32_32x32x16_bf16 v[48:63], v[108:111], v[88:91], v[48:63]
    v_mfma_f32_32x32x16_bf16 v[64:79], v[108:111], v[92:95], v[64:79]
    s_waitcnt vmcnt(3)
    s_barrier
    s_mov_b32 s33, 768
    s_mov_b32 s34, 1327104
    s_add_u32 m0, s31, 0
    s_nop 0
    buffer_load_dwordx4 v5, s[4:7], s33 offen lds
    s_add_u32 m0, s31, 1024
    s_nop 0
    buffer_load_dwordx4 v6, s[4:7], s33 offen lds
    s_add_u32 m0, s32, 49152
    s_nop 0
    buffer_load_dwordx4 v7, s[8:11], s34 offen lds
    ds_read_b128 v[80:83], v8 offset:16384
    ds_read_b128 v[84:87], v10 offset:16384
    ds_read_b64_tr_b16 v[96:97], v12 offset:8192
    ds_read_b64_tr_b16 v[98:99], v12 offset:9216
    ds_read_b64_tr_b16 v[100:101], v13 offset:8192
    ds_read_b64_tr_b16 v[102:103], v13 offset:9216
    ds_read_b128 v[88:91], v9 offset:16384
    ds_read_b128 v[92:95], v11 offset:16384
    ds_read_b64_tr_b16 v[104:105], v12 offset:12288
    ds_read_b64_tr_b16 v[106:107], v12 offset:13312
    ds_read_b64_tr_b16 v[108:109], v13 offset:12288
    ds_read_b64_tr_b16 v[110:111], v13 offset:13312
    s_waitcnt lgkmcnt(6)
    v_mfma_f32_32x32x16_bf16 v[16:31], v[96:99], v[80:83], v[16:31]
    v_mfma_f32_32x32x16_bf16 v[32:47], v[96:99], v[84:87], v[32:47]
    v_mfma_f32_32x32x16_bf16 v[48:63], v[100:103], v[80:83], v[48:63]
    v_mfma_f32_32x32x16_bf16 v[64:79], v[100:103], v[84:87], v[64:79]
    s_waitcnt lgkmcnt(0)
    v_mfma_f32_32x32x16_bf16 v[16:31], v[104:107], v[88:91], v[16:31]
    v_mfma_f32_32x32x16_bf16 v[32:47], v[104:107], v[92:95], v[32:47]
    v_mfma_f32_32x32x16_bf16 v[48:63], v[108:111], v[88:91], v[48:63]
    v_mfma_f32_32x32x16_bf16 v[64:79], v[108:111], v[92:95], v[64:79]
    s_waitcnt vmcnt(3)
    s_barrier
    s_mov_b32 s33, 832
    s_mov_b32 s34, 1437696
    s_add_u32 m0, s31, 16384
    s_nop 0
    buffer_load_dwordx4 v5, s[4:7], s33 offen lds
    s_add_u32 m0, s31, 17408
    s_nop 0
    buffer_load_dwordx4 v6, s[4:7], s33 offen lds
    s_add_u32 m0, s32, 57344
    s_nop 0
    buffer_load_dwordx4 v7, s[8:11], s34 offen lds
    ds_read_b128 v[80:83], v8 offset:32768
    ds_read_b128 v[84:87], v10 offset:32768
    ds_read_b64_tr_b16 v[96:97], v12 offset:16384
    ds_read_b64_tr_b16 v[98:99], v12 offset:17408
    ds_read_b64_tr_b16 v[100:101], v13 offset:16384
    ds_read_b64_tr_b16 v[102:103], v13 offset:17408
    ds_read_b128 v[88:91], v9 offset:32768
    ds_read_b128 v[92:95], v11 offset:32768
    ds_read_b64_tr_b16 v[104:105], v12 offset:20480
    ds_read_b64_tr_b16 v[106:107], v12 offset:21504
    ds_read_b64_tr_b16 v[108:109], v13 offset:20480
    ds_read_b64_tr_b16 v[110:111], v13 offset:21504
    s_waitcnt lgkmcnt(6)
    v_mfma_f32_32x32x16_bf16 v[16:31], v[96:99], v[80:83], v[16:31]
    v_mfma_f32_32x32x16_bf16 v[32:47], v[96:99], v[84:87], v[32:47]
    v_mfma_f32_32x32x16_bf16 v[48:63], v[100:103], v[80:83], v[48:63]
    v_mfma_f32_32x32x16_bf16 v[64:79], v[100:103], v[84:87], v[64:79]
    s_waitcnt lgkmcnt(0)
    v_mfma_f32_32x32x16_bf16 v[16:31], v[104:107], v[88:91], v[16:31]
    v_mfma_f32_32x32x16_bf16 v[32:47], v[104:107], v[92:95], v[32:47]
    v_mfma_f32_32x32x16_bf16 v[48:63], v[108:111], v[88:91], v[48:63]
    v_mfma_f32_32x32x16_bf16 v[64:79], v[108:111], v[92:95], v[64:79]
    s_waitcnt vmcnt(3)
    s_barrier
    s_mov_b32 s33, 896
    s_mov_b32 s34, 1548288
    s_add_u32 m0, s31, 32768
    s_nop 0
    buffer_load_dwordx4 v5, s[4:7], s33 offen lds
    s_add_u32 m0, s31, 33792
    s_nop 0
    buffer_load_dwordx4 v6, s[4:7], s33 offen lds
    s_add_u32 m0, s32, 65536
    s_nop 0
    buffer_load_dwordx4 v7, s[8:11], s34 offen lds
    ds_read_b128 v[80:83], v8 offset:0
    ds_read_b128 v[84:87], v10 offset:0
    ds_read_b64_tr_b16 v[96:97], v12 offset:0
    ds_read_b64_tr_b16 v[98:99], v12 offset:1024
    ds_read_b64_tr_b16 v[100:101], v13 offset:0
    ds_read_b64_tr_b16 v[102:103], v13 offset:1024
    ds_read_b128 v[88:91], v9 offset:0
    ds_read_b128 v[92:95], v11 offset:0
    ds_read_b64_tr_b16 v[104:105], v12 offset:4096
    ds_read_b64_tr_b16 v[106:107], v12 offset:5120
    ds_read_b64_tr_b16 v[108:109], v13 offset:4096
    ds_read_b64_tr_b16 v[110:111], v13 offset:5120
    s_waitcnt lgkmcnt(6)
    v_mfma_f32_32x32x16_bf16 v[16:31], v[96:99], v[80:83], v[16:31]
    v_mfma_f32_32x32x16_bf16 v[32:47], v[96:99], v[84:87], v[32:47]
    v_mfma_f32_32x32x16_bf16 v[48:63], v[100:103], v[80:83], v[48:63]
    v_mfma_f32_32x32x16_bf16 v[64:79], v[100:103], v[84:87], v[64:79]
    s_waitcnt lgkmcnt(0)
    v_mfma_f32_32x32x16_bf16 v[16:31], v[104:107], v[88:91], v[16:31]
    v_mfma_f32_32x32x16_bf16 v[32:47], v[104:107], v[92:95], v[32:47]
    v_mfma_f32_32x32x16_bf16 v[48:63], v[108:111], v[88:91], v[48:63]
    v_mfma_f32_32x32x16_bf16 v[64:79], v[108:111], v[92:95], v[64:79]
    s_waitcnt vmcnt(3)
    s_barrier
    s_mov_b32 s33, 960
    s_mov_b32 s34, 1658880
    s_add_u32 m0, s31, 0
    s_nop 0
    buffer_load_dwordx4 v5, s[4:7], s33 offen lds
    s_add_u32 m0, s31, 1024
    s_nop 0
    buffer_load_dwordx4 v6, s[4:7], s33 offen lds
    s_add_u32 m0, s32, 49152
    s_nop 0
    buffer_load_dwordx4 v7, s[8:11], s34 offen lds
    ds_read_b128 v[80:83], v8 offset:16384
    ds_read_b128 v[84:87], v10 offset:16384
    ds_read_b64_tr_b16 v[96:97], v12 offset:8192
    ds_read_b64_tr_b16 v[98:99], v12 offset:9216
    ds_read_b64_tr_b16 v[100:101], v13 offset:8192
    ds_read_b64_tr_b16 v[102:103], v13 offset:9216
    ds_read_b128 v[88:91], v9 offset:16384
    ds_read_b128 v[92:95], v11 offset:16384
    ds_read_b64_tr_b16 v[104:105], v12 offset:12288
    ds_read_b64_tr_b16 v[106:107], v12 offset:13312
    ds_read_b64_tr_b16 v[108:109], v13 offset:12288
    ds_read_b64_tr_b16 v[110:111], v13 offset:13312
    s_waitcnt lgkmcnt(6)
    v_mfma_f32_32x32x16_bf16 v[16:31], v[96:99], v[80:83], v[16:31]
    v_mfma_f32_32x32x16_bf16 v[32:47], v[96:99], v[84:87], v[32:47]
    v_mfma_f32_32x32x16_bf16 v[48:63], v[100:103], v[80:83], v[48:63]
    v_mfma_f32_32x32x16_bf16 v[64:79], v[100:103], v[84:87], v[64:79]
    s_waitcnt lgkmcnt(0)
    v_mfma_f32_32x32x16_bf16 v[16:31], v[104:107], v[88:91], v[16:31]
    v_mfma_f32_32x32x16_bf16 v[32:47], v[104:107], v[92:95], v[32:47]
    v_mfma_f32_32x32x16_bf16 v[48:63], v[108:111], v[88:91], v[48:63]
    v_mfma_f32_32x32x16_bf16 v[64:79], v[108:111], v[92:95], v[64:79]
    s_waitcnt vmcnt(3)
    s_barrier
    s_mov_b32 s33, 1024
    s_mov_b32 s34, 1769472
    s_add_u32 m0, s31, 16384
    s_nop 0
    buffer_load_dwordx4 v5, s[4:7], s33 offen lds
    s_add_u32 m0, s31, 17408
    s_nop 0
    buffer_load_dwordx4 v6, s[4:7], s33 offen lds
    s_add_u32 m0, s32, 57344
    s_nop 0
    buffer_load_dwordx4 v7, s[8:11], s34 offen lds
    ds_read_b128 v[80:83], v8 offset:32768
    ds_read_b128 v[84:87], v10 offset:32768
    ds_read_b64_tr_b16 v[96:97], v12 offset:16384
    ds_read_b64_tr_b16 v[98:99], v12 offset:17408
    ds_read_b64_tr_b16 v[100:101], v13 offset:16384
    ds_read_b64_tr_b16 v[102:103], v13 offset:17408
    ds_read_b128 v[88:91], v9 offset:32768
    ds_read_b128 v[92:95], v11 offset:32768
    ds_read_b64_tr_b16 v[104:105], v12 offset:20480
    ds_read_b64_tr_b16 v[106:107], v12 offset:21504
    ds_read_b64_tr_b16 v[108:109], v13 offset:20480
    ds_read_b64_tr_b16 v[110:111], v13 offset:21504
    s_waitcnt lgkmcnt(6)
    v_mfma_f32_32x32x16_bf16 v[16:31], v[96:99], v[80:83], v[16:31]
    v_mfma_f32_32x32x16_bf16 v[32:47], v[96:99], v[84:87], v[32:47]
    v_mfma_f32_32x32x16_bf16 v[48:63], v[100:103], v[80:83], v[48:63]
    v_mfma_f32_32x32x16_bf16 v[64:79], v[100:103], v[84:87], v[64:79]
    s_waitcnt lgkmcnt(0)
    v_mfma_f32_32x32x16_bf16 v[16:31], v[104:107], v[88:91], v[16:31]
    v_mfma_f32_32x32x16_bf16 v[32:47], v[104:107], v[92:95], v[32:47]
    v_mfma_f32_32x32x16_bf16 v[48:63], v[108:111], v[88:91], v[48:63]
    v_mfma_f32_32x32x16_bf16 v[64:79], v[108:111], v[92:95], v[64:79]
    s_waitcnt vmcnt(3)
    s_barrier
    s_mov_b32 s33, 1088
    s_mov_b32 s34, 1880064
    s_add_u32 m0, s31, 32768
    s_nop 0
    buffer_load_dwordx4 v5, s[4:7], s33 offen lds
    s_add_u32 m0, s31, 33792
    s_nop 0
    buffer_load_dwordx4 v6, s[4:7], s33 offen lds
    s_add_u32 m0, s32, 65536
    s_nop 0
    buffer_load_dwordx4 v7, s[8:11], s34 offen lds
    ds_read_b128 v[80:83], v8 offset:0
    ds_read_b128 v[84:87], v10 offset:0
    ds_read_b64_tr_b16 v[96:97], v12 offset:0
    ds_read_b64_tr_b16 v[98:99], v12 offset:1024
    ds_read_b64_tr_b16 v[100:101], v13 offset:0
    ds_read_b64_tr_b16 v[102:103], v13 offset:1024
    ds_read_b128 v[88:91], v9 offset:0
    ds_read_b128 v[92:95], v11 offset:0
    ds_read_b64_tr_b16 v[104:105], v12 offset:4096
    ds_read_b64_tr_b16 v[106:107], v12 offset:5120
    ds_read_b64_tr_b16 v[108:109], v13 offset:4096
    ds_read_b64_tr_b16 v[110:111], v13 offset:5120
    s_waitcnt lgkmcnt(6)
    v_mfma_f32_32x32x16_bf16 v[16:31], v[96:99], v[80:83], v[16:31]
    v_mfma_f32_32x32x16_bf16 v[32:47], v[96:99], v[84:87], v[32:47]
    v_mfma_f32_32x32x16_bf16 v[48:63], v[100:103], v[80:83], v[48:63]
    v_mfma_f32_32x32x16_bf16 v[64:79], v[100:103], v[84:87], v[64:79]
    s_waitcnt lgkmcnt(0)
    v_mfma_f32_32x32x16_bf16 v[16:31], v[104:107], v[88:91], v[16:31]
    v_mfma_f32_32x32x16_bf16 v[32:47], v[104:107], v[92:95], v[32:47]
    v_mfma_f32_32x32x16_bf16 v[48:63], v[108:111], v[88:91], v[48:63]
    v_mfma_f32_32x32x16_bf16 v[64:79], v[108:111], v[92:95], v[64:79]
    s_waitcnt vmcnt(3)
    s_barrier
    s_mov_b32 s33, 1152
    s_mov_b32 s34, 1990656
    s_add_u32 m0, s31, 0
    s_nop 0
    buffer_load_dwordx4 v5, s[4:7], s33 offen lds
    s_add_u32 m0, s31, 1024
    s_nop 0
    buffer_load_dwordx4 v6, s[4:7], s33 offen lds
    s_add_u32 m0, s32, 49152
    s_nop 0
    buffer_load_dwordx4 v7, s[8:11], s34 offen lds
    ds_read_b128 v[80:83], v8 offset:16384
    ds_read_b128 v[84:87], v10 offset:16384
    ds_read_b64_tr_b16 v[96:97], v12 offset:8192
    ds_read_b64_tr_b16 v[98:99], v12 offset:9216
    ds_read_b64_tr_b16 v[100:101], v13 offset:8192
    ds_read_b64_tr_b16 v[102:103], v13 offset:9216
    ds_read_b128 v[88:91], v9 offset:16384
    ds_read_b128 v[92:95], v11 offset:16384
    ds_read_b64_tr_b16 v[104:105], v12 offset:12288
    ds_read_b64_tr_b16 v[106:107], v12 offset:13312
    ds_read_b64_tr_b16 v[108:109], v13 offset:12288
    ds_read_b64_tr_b16 v[110:111], v13 offset:13312
    s_waitcnt lgkmcnt(6)
    v_mfma_f32_32x32x16_bf16 v[16:31], v[96:99], v[80:83], v[16:31]
    v_mfma_f32_32x32x16_bf16 v[32:47], v[96:99], v[84:87], v[32:47]
    v_mfma_f32_32x32x16_bf16 v[48:63], v[100:103], v[80:83], v[48:63]
    v_mfma_f32_32x32x16_bf16 v[64:79], v[100:103], v[84:87], v[64:79]
    s_waitcnt lgkmcnt(0)
    v_mfma_f32_32x32x16_bf16 v[16:31], v[104:107], v[88:91], v[16:31]
    v_mfma_f32_32x32x16_bf16 v[32:47], v[104:107], v[92:95], v[32:47]
    v_mfma_f32_32x32x16_bf16 v[48:63], v[108:111], v[88:91], v[48:63]
    v_mfma_f32_32x32x16_bf16 v[64:79], v[108:111], v[92:95], v[64:79]
    s_waitcnt vmcnt(3)
    s_barrier
    s_mov_b32 s33, 1216
    s_mov_b32 s34, 2101248
    s_add_u32 m0, s31, 16384
    s_nop 0
    buffer_load_dwordx4 v5, s[4:7], s33 offen lds
    s_add_u32 m0, s31, 17408
    s_nop 0
    buffer_load_dwordx4 v6, s[4:7], s33 offen lds
    s_add_u32 m0, s32, 57344
    s_nop 0
    buffer_load_dwordx4 v7, s[8:11], s34 offen lds
    ds_read_b128 v[80:83], v8 offset:32768
    ds_read_b128 v[84:87], v10 offset:32768
    ds_read_b64_tr_b16 v[96:97], v12 offset:16384
    ds_read_b64_tr_b16 v[98:99], v12 offset:17408
    ds_read_b64_tr_b16 v[100:101], v13 offset:16384
    ds_read_b64_tr_b16 v[102:103], v13 offset:17408
    ds_read_b128 v[88:91], v9 offset:32768
    ds_read_b128 v[92:95], v11 offset:32768
    ds_read_b64_tr_b16 v[104:105], v12 offset:20480
    ds_read_b64_tr_b16 v[106:107], v12 offset:21504
    ds_read_b64_tr_b16 v[108:109], v13 offset:20480
    ds_read_b64_tr_b16 v[110:111], v13 offset:21504
    s_waitcnt lgkmcnt(6)
    v_mfma_f32_32x32x16_bf16 v[16:31], v[96:99], v[80:83], v[16:31]
    v_mfma_f32_32x32x16_bf16 v[32:47], v[96:99], v[84:87], v[32:47]
    v_mfma_f32_32x32x16_bf16 v[48:63], v[100:103], v[80:83], v[48:63]
    v_mfma_f32_32x32x16_bf16 v[64:79], v[100:103], v[84:87], v[64:79]
    s_waitcnt lgkmcnt(0)
    v_mfma_f32_32x32x16_bf16 v[16:31], v[104:107], v[88:91], v[16:31]
    v_mfma_f32_32x32x16_bf16 v[32:47], v[104:107], v[92:95], v[32:47]
    v_mfma_f32_32x32x16_bf16 v[48:63], v[108:111], v[88:91], v[48:63]
    v_mfma_f32_32x32x16_bf16 v[64:79], v[108:111], v[92:95], v[64:79]
    s_waitcnt vmcnt(3)
    s_barrier
    ds_read_b128 v[80:83], v8 offset:0
    ds_read_b128 v[84:87], v10 offset:0
    ds_read_b64_tr_b16 v[96:97], v12 offset:0
    ds_read_b64_tr_b16 v[98:99], v12 offset:1024
    ds_read_b64_tr_b16 v[100:101], v13 offset:0
    ds_read_b64_tr_b16 v[102:103], v13 offset:1024
    ds_read_b128 v[88:91], v9 offset:0
    ds_read_b128 v[92:95], v11 offset:0
    ds_read_b64_tr_b16 v[104:105], v12 offset:4096
    ds_read_b64_tr_b16 v[106:107], v12 offset:5120
    ds_read_b64_tr_b16 v[108:109], v13 offset:4096
    ds_read_b64_tr_b16 v[110:111], v13 offset:5120
    s_waitcnt lgkmcnt(6)
    v_mfma_f32_32x32x16_bf16 v[16:31], v[96:99], v[80:83], v[16:31]
    v_mfma_f32_32x32x16_bf16 v[32:47], v[96:99], v[84:87], v[32:47]
    v_mfma_f32_32x32x16_bf16 v[48:63], v[100:103], v[80:83], v[48:63]
    v_mfma_f32_32x32x16_bf16 v[64:79], v[100:103], v[84:87], v[64:79]
    s_waitcnt lgkmcnt(0)
    v_mfma_f32_32x32x16_bf16 v[16:31], v[104:107], v[88:91], v[16:31]
    v_mfma_f32_32x32x16_bf16 v[32:47], v[104:107], v[92:95], v[32:47]
    v_mfma_f32_32x32x16_bf16 v[48:63], v[108:111], v[88:91], v[48:63]
    v_mfma_f32_32x32x16_bf16 v[64:79], v[108:111], v[92:95], v[64:79]
    s_waitcnt vmcnt(0)
    s_barrier
    ds_read_b128 v[80:83], v8 offset:16384
    ds_read_b128 v[84:87], v10 offset:16384
    ds_read_b64_tr_b16 v[96:97], v12 offset:8192
    ds_read_b64_tr_b16 v[98:99], v12 offset:9216
    ds_read_b64_tr_b16 v[100:101], v13 offset:8192
    ds_read_b64_tr_b16 v[102:103], v13 offset:9216
    ds_read_b128 v[88:91], v9 offset:16384
    ds_read_b128 v[92:95], v11 offset:16384
    ds_read_b64_tr_b16 v[104:105], v12 offset:12288
    ds_read_b64_tr_b16 v[106:107], v12 offset:13312
    ds_read_b64_tr_b16 v[108:109], v13 offset:12288
    ds_read_b64_tr_b16 v[110:111], v13 offset:13312
    s_waitcnt lgkmcnt(6)
    v_mfma_f32_32x32x16_bf16 v[16:31], v[96:99], v[80:83], v[16:31]
    v_mfma_f32_32x32x16_bf16 v[32:47], v[96:99], v[84:87], v[32:47]
    v_mfma_f32_32x32x16_bf16 v[48:63], v[100:103], v[80:83], v[48:63]
    v_mfma_f32_32x32x16_bf16 v[64:79], v[100:103], v[84:87], v[64:79]
    s_waitcnt lgkmcnt(0)
    v_mfma_f32_32x32x16_bf16 v[16:31], v[104:107], v[88:91], v[16:31]
    v_mfma_f32_32x32x16_bf16 v[32:47], v[104:107], v[92:95], v[32:47]
    v_mfma_f32_32x32x16_bf16 v[48:63], v[108:111], v[88:91], v[48:63]
    v_mfma_f32_32x32x16_bf16 v[64:79], v[108:111], v[92:95], v[64:79]
    s_nop 15
    s_nop 3
    s_barrier
    s_lshl_b32 s35, s28, 6
    s_add_u32 s35, s35, s25
    s_cmp_ge_u32 s35, 1728
    s_cbranch_scc1 g1skip_1
    s_mul_i32 s23, s26, 9216
    v_and_b32 v2, 31, v1
    v_mul_u32_u24 v2, 144, v2
    v_lshrrev_b32 v3, 5, v1
    v_lshlrev_b32 v3, 3, v3
    v_add3_u32 v112, v2, v3, s23
    v_lshrrev_b32 v2, 3, v1
    v_mul_u32_u24 v4, 144, v2
    v_and_b32 v3, 7, v1
    v_lshlrev_b32 v3, 4, v3
    v_add3_u32 v113, v4, v3, s23
    s_lshl_b32 s22, s27, 6
    s_add_u32 s22, s22, s24
    v_add_u32 v2, s22, v2
    v_mul_u32_u24 v114, 3456, v2
    s_lshl_b32 s35, s35, 1
    v_add3_u32 v114, v114, v3, s35
    v_cvt_pk_bf16_f32 v80, v16, v17
    v_cvt_pk_bf16_f32 v81, v18, v19
    v_cvt_pk_bf16_f32 v82, v20, v21
    v_cvt_pk_bf16_f32 v83, v22, v23
    v_lshlrev_b32 v16, 16, v80
    v_and_b32 v17, 0xffff0000, v80
    v_lshlrev_b32 v18, 16, v81
    v_and_b32 v19, 0xffff0000, v81
    v_lshlrev_b32 v20, 16, v82
    v_and_b32 v21, 0xffff0000, v82
    v_lshlrev_b32 v22, 16, v83
    v_and_b32 v23, 0xffff0000, v83
    v_mul_f32 v84, 0xbfb8aa3b, v16
    v_mul_f32 v85, 0xbfb8aa3b, v17
    v_mul_f32 v86, 0xbfb8aa3b, v18
    v_mul_f32 v87, 0xbfb8aa3b, v19
    v_mul_f32 v88, 0xbfb8aa3b, v20
    v_mul_f32 v89, 0xbfb8aa3b, v21
    v_mul_f32 v90, 0xbfb8aa3b, v22
    v_mul_f32 v91, 0xbfb8aa3b, v23
    v_exp_f32 v84, v84
    v_exp_f32 v85, v85
    v_exp_f32 v86, v86
    v_exp_f32 v87, v87
    v_exp_f32 v88, v88
    v_exp_f32 v89, v89
    v_exp_f32 v90, v90
    v_exp_f32 v91, v91
    v_add_f32 v84, 1.0, v84
    v_add_f32 v85, 1.0, v85
    v_add_f32 v86, 1.0, v86
    v_add_f32 v87, 1.0, v87
    v_add_f32 v88, 1.0, v88
    v_add_f32 v89, 1.0, v89
    v_add_f32 v90, 1.0, v90
    v_add_f32 v91, 1.0, v91
    v_rcp_f32 v84, v84
    v_rcp_f32 v85, v85
    v_rcp_f32 v86, v86
    v_rcp_f32 v87, v87
    v_rcp_f32 v88, v88
    v_rcp_f32 v89, v89
    v_rcp_f32 v90, v90
    v_rcp_f32 v91, v91
    v_mul_f32 v16, v16, v84
    v_mul_f32 v17, v17, v85
    v_mul_f32 v18, v18, v86
    v_mul_f32 v19, v19, v87
    v_mul_f32 v20, v20, v88
    v_mul_f32 v21, v21, v89
    v_mul_f32 v22, v22, v90
    v_mul_f32 v23, v23, v91
    v_cvt_pk_bf16_f32 v80, v16, v17
    v_cvt_pk_bf16_f32 v81, v18, v19
    v_cvt_pk_bf16_f32 v82, v20, v21
    v_cvt_pk_bf16_f32 v83, v22, v23
    ds_write_b64 v112, v[80:81] offset:0
    ds_write_b64 v112, v[82:83] offset:16
    v_cvt_pk_bf16_f32 v80, v24, v25
    v_cvt_pk_bf16_f32 v81, v26, v27
    v_cvt_pk_bf16_f32 v82, v28, v29
    v_cvt_pk_bf16_f32 v83, v30, v31
    v_lshlrev_b32 v24, 16, v80
    v_and_b32 v25, 0xffff0000, v80
    v_lshlrev_b32 v26, 16, v81
    v_and_b32 v27, 0xffff0000, v81
    v_lshlrev_b32 v28, 16, v82
    v_and_b32 v29, 0xffff0000, v82
    v_lshlrev_b32 v30, 16, v83
    v_and_b32 v31, 0xffff0000, v83
    v_mul_f32 v84, 0xbfb8aa3b, v24
    v_mul_f32 v85, 0xbfb8aa3b, v25
    v_mul_f32 v86, 0xbfb8aa3b, v26
    v_mul_f32 v87, 0xbfb8aa3b, v27
    v_mul_f32 v88, 0xbfb8aa3b, v28
    v_mul_f32 v89, 0xbfb8aa3b, v29
    v_mul_f32 v90, 0xbfb8aa3b, v30
    v_mul_f32 v91, 0xbfb8aa3b, v31
    v_exp_f32 v84, v84
    v_exp_f32 v85, v85
    v_exp_f32 v86, v86
    v_exp_f32 v87, v87
    v_exp_f32 v88, v88
    v_exp_f32 v89, v89
    v_exp_f32 v90, v90
    v_exp_f32 v91, v91
    v_add_f32 v84, 1.0, v84
    v_add_f32 v85, 1.0, v85
    v_add_f32 v86, 1.0, v86
    v_add_f32 v87, 1.0, v87
    v_add_f32 v88, 1.0, v88
    v_add_f32 v89, 1.0, v89
    v_add_f32 v90, 1.0, v90
    v_add_f32 v91, 1.0, v91
    v_rcp_f32 v84, v84
    v_rcp_f32 v85, v85
    v_rcp_f32 v86, v86
    v_rcp_f32 v87, v87
    v_rcp_f32 v88, v88
    v_rcp_f32 v89, v89
    v_rcp_f32 v90, v90
    v_rcp_f32 v91, v91
    v_mul_f32 v24, v24, v84
    v_mul_f32 v25, v25, v85
    v_mul_f32 v26, v26, v86
    v_mul_f32 v27, v27, v87
    v_mul_f32 v28, v28, v88
    v_mul_f32 v29, v29, v89
    v_mul_f32 v30, v30, v90
    v_mul_f32 v31, v31, v91
    v_cvt_pk_bf16_f32 v80, v24, v25
    v_cvt_pk_bf16_f32 v81, v26, v27
    v_cvt_pk_bf16_f32 v82, v28, v29
    v_cvt_pk_bf16_f32 v83, v30, v31
    ds_write_b64 v112, v[80:81] offset:32
    ds_write_b64 v112, v[82:83] offset:48
    v_cvt_pk_bf16_f32 v80, v32, v33
    v_cvt_pk_bf16_f32 v81, v34, v35
    v_cvt_pk_bf16_f32 v82, v36, v37
    v_cvt_pk_bf16_f32 v83, v38, v39
    v_lshlrev_b32 v32, 16, v80
    v_and_b32 v33, 0xffff0000, v80
    v_lshlrev_b32 v34, 16, v81
    v_and_b32 v35, 0xffff0000, v81
    v_lshlrev_b32 v36, 16, v82
    v_and_b32 v37, 0xffff0000, v82
    v_lshlrev_b32 v38, 16, v83
    v_and_b32 v39, 0xffff0000, v83
    v_mul_f32 v84, 0xbfb8aa3b, v32
    v_mul_f32 v85, 0xbfb8aa3b, v33
    v_mul_f32 v86, 0xbfb8aa3b, v34
    v_mul_f32 v87, 0xbfb8aa3b, v35
    v_mul_f32 v88, 0xbfb8aa3b, v36
    v_mul_f32 v89, 0xbfb8aa3b, v37
    v_mul_f32 v90, 0xbfb8aa3b, v38
    v_mul_f32 v91, 0xbfb8aa3b, v39
    v_exp_f32 v84, v84
    v_exp_f32 v85, v85
    v_exp_f32 v86, v86
    v_exp_f32 v87, v87
    v_exp_f32 v88, v88
    v_exp_f32 v89, v89
    v_exp_f32 v90, v90
    v_exp_f32 v91, v91
    v_add_f32 v84, 1.0, v84
    v_add_f32 v85, 1.0, v85
    v_add_f32 v86, 1.0, v86
    v_add_f32 v87, 1.0, v87
    v_add_f32 v88, 1.0, v88
    v_add_f32 v89, 1.0, v89
    v_add_f32 v90, 1.0, v90
    v_add_f32 v91, 1.0, v91
    v_rcp_f32 v84, v84
    v_rcp_f32 v85, v85
    v_rcp_f32 v86, v86
    v_rcp_f32 v87, v87
    v_rcp_f32 v88, v88
    v_rcp_f32 v89, v89
    v_rcp_f32 v90, v90
    v_rcp_f32 v91, v91
    v_mul_f32 v32, v32, v84
    v_mul_f32 v33, v33, v85
    v_mul_f32 v34, v34, v86
    v_mul_f32 v35, v35, v87
    v_mul_f32 v36, v36, v88
    v_mul_f32 v37, v37, v89
    v_mul_f32 v38, v38, v90
    v_mul_f32 v39, v39, v91
    v_cvt_pk_bf16_f32 v80, v32, v33
    v_cvt_pk_bf16_f32 v81, v34, v35
    v_cvt_pk_bf16_f32 v82, v36, v37
    v_cvt_pk_bf16_f32 v83, v38, v39
    ds_write_b64 v112, v[80:81] offset:4608
    ds_write_b64 v112, v[82:83] offset:4624
    v_cvt_pk_bf16_f32 v80, v40, v41
    v_cvt_pk_bf16_f32 v81, v42, v43
    v_cvt_pk_bf16_f32 v82, v44, v45
    v_cvt_pk_bf16_f32 v83, v46, v47
    v_lshlrev_b32 v40, 16, v80
    v_and_b32 v41, 0xffff0000, v80
    v_lshlrev_b32 v42, 16, v81
    v_and_b32 v43, 0xffff0000, v81
    v_lshlrev_b32 v44, 16, v82
    v_and_b32 v45, 0xffff0000, v82
    v_lshlrev_b32 v46, 16, v83
    v_and_b32 v47, 0xffff0000, v83
    v_mul_f32 v84, 0xbfb8aa3b, v40
    v_mul_f32 v85, 0xbfb8aa3b, v41
    v_mul_f32 v86, 0xbfb8aa3b, v42
    v_mul_f32 v87, 0xbfb8aa3b, v43
    v_mul_f32 v88, 0xbfb8aa3b, v44
    v_mul_f32 v89, 0xbfb8aa3b, v45
    v_mul_f32 v90, 0xbfb8aa3b, v46
    v_mul_f32 v91, 0xbfb8aa3b, v47
    v_exp_f32 v84, v84
    v_exp_f32 v85, v85
    v_exp_f32 v86, v86
    v_exp_f32 v87, v87
    v_exp_f32 v88, v88
    v_exp_f32 v89, v89
    v_exp_f32 v90, v90
    v_exp_f32 v91, v91
    v_add_f32 v84, 1.0, v84
    v_add_f32 v85, 1.0, v85
    v_add_f32 v86, 1.0, v86
    v_add_f32 v87, 1.0, v87
    v_add_f32 v88, 1.0, v88
    v_add_f32 v89, 1.0, v89
    v_add_f32 v90, 1.0, v90
    v_add_f32 v91, 1.0, v91
    v_rcp_f32 v84, v84
    v_rcp_f32 v85, v85
    v_rcp_f32 v86, v86
    v_rcp_f32 v87, v87
    v_rcp_f32 v88, v88
    v_rcp_f32 v89, v89
    v_rcp_f32 v90, v90
    v_rcp_f32 v91, v91
    v_mul_f32 v40, v40, v84
    v_mul_f32 v41, v41, v85
    v_mul_f32 v42, v42, v86
    v_mul_f32 v43, v43, v87
    v_mul_f32 v44, v44, v88
    v_mul_f32 v45, v45, v89
    v_mul_f32 v46, v46, v90
    v_mul_f32 v47, v47, v91
    v_cvt_pk_bf16_f32 v80, v40, v41
    v_cvt_pk_bf16_f32 v81, v42, v43
    v_cvt_pk_bf16_f32 v82, v44, v45
    v_cvt_pk_bf16_f32 v83, v46, v47
    ds_write_b64 v112, v[80:81] offset:4640
    ds_write_b64 v112, v[82:83] offset:4656
    v_cvt_pk_bf16_f32 v80, v48, v49
    v_cvt_pk_bf16_f32 v81, v50, v51
    v_cvt_pk_bf16_f32 v82, v52, v53
    v_cvt_pk_bf16_f32 v83, v54, v55
    v_lshlrev_b32 v48, 16, v80
    v_and_b32 v49, 0xffff0000, v80
    v_lshlrev_b32 v50, 16, v81
    v_and_b32 v51, 0xffff0000, v81
    v_lshlrev_b32 v52, 16, v82
    v_and_b32 v53, 0xffff0000, v82
    v_lshlrev_b32 v54, 16, v83
    v_and_b32 v55, 0xffff0000, v83
    v_mul_f32 v84, 0xbfb8aa3b, v48
    v_mul_f32 v85, 0xbfb8aa3b, v49
    v_mul_f32 v86, 0xbfb8aa3b, v50
    v_mul_f32 v87, 0xbfb8aa3b, v51
    v_mul_f32 v88, 0xbfb8aa3b, v52
    v_mul_f32 v89, 0xbfb8aa3b, v53
    v_mul_f32 v90, 0xbfb8aa3b, v54
    v_mul_f32 v91, 0xbfb8aa3b, v55
    v_exp_f32 v84, v84
    v_exp_f32 v85, v85
    v_exp_f32 v86, v86
    v_exp_f32 v87, v87
    v_exp_f32 v88, v88
    v_exp_f32 v89, v89
    v_exp_f32 v90, v90
    v_exp_f32 v91, v91
    v_add_f32 v84, 1.0, v84
    v_add_f32 v85, 1.0, v85
    v_add_f32 v86, 1.0, v86
    v_add_f32 v87, 1.0, v87
    v_add_f32 v88, 1.0, v88
    v_add_f32 v89, 1.0, v89
    v_add_f32 v90, 1.0, v90
    v_add_f32 v91, 1.0, v91
    v_rcp_f32 v84, v84
    v_rcp_f32 v85, v85
    v_rcp_f32 v86, v86
    v_rcp_f32 v87, v87
    v_rcp_f32 v88, v88
    v_rcp_f32 v89, v89
    v_rcp_f32 v90, v90
    v_rcp_f32 v91, v91
    v_mul_f32 v48, v48, v84
    v_mul_f32 v49, v49, v85
    v_mul_f32 v50, v50, v86
    v_mul_f32 v51, v51, v87
    v_mul_f32 v52, v52, v88
    v_mul_f32 v53, v53, v89
    v_mul_f32 v54, v54, v90
    v_mul_f32 v55, v55, v91
    v_cvt_pk_bf16_f32 v80, v48, v49
    v_cvt_pk_bf16_f32 v81, v50, v51
    v_cvt_pk_bf16_f32 v82, v52, v53
    v_cvt_pk_bf16_f32 v83, v54, v55
    ds_write_b64 v112, v[80:81] offset:64
    ds_write_b64 v112, v[82:83] offset:80
    v_cvt_pk_bf16_f32 v80, v56, v57
    v_cvt_pk_bf16_f32 v81, v58, v59
    v_cvt_pk_bf16_f32 v82, v60, v61
    v_cvt_pk_bf16_f32 v83, v62, v63
    v_lshlrev_b32 v56, 16, v80
    v_and_b32 v57, 0xffff0000, v80
    v_lshlrev_b32 v58, 16, v81
    v_and_b32 v59, 0xffff0000, v81
    v_lshlrev_b32 v60, 16, v82
    v_and_b32 v61, 0xffff0000, v82
    v_lshlrev_b32 v62, 16, v83
    v_and_b32 v63, 0xffff0000, v83
    v_mul_f32 v84, 0xbfb8aa3b, v56
    v_mul_f32 v85, 0xbfb8aa3b, v57
    v_mul_f32 v86, 0xbfb8aa3b, v58
    v_mul_f32 v87, 0xbfb8aa3b, v59
    v_mul_f32 v88, 0xbfb8aa3b, v60
    v_mul_f32 v89, 0xbfb8aa3b, v61
    v_mul_f32 v90, 0xbfb8aa3b, v62
    v_mul_f32 v91, 0xbfb8aa3b, v63
    v_exp_f32 v84, v84
    v_exp_f32 v85, v85
    v_exp_f32 v86, v86
    v_exp_f32 v87, v87
    v_exp_f32 v88, v88
    v_exp_f32 v89, v89
    v_exp_f32 v90, v90
    v_exp_f32 v91, v91
    v_add_f32 v84, 1.0, v84
    v_add_f32 v85, 1.0, v85
    v_add_f32 v86, 1.0, v86
    v_add_f32 v87, 1.0, v87
    v_add_f32 v88, 1.0, v88
    v_add_f32 v89, 1.0, v89
    v_add_f32 v90, 1.0, v90
    v_add_f32 v91, 1.0, v91
    v_rcp_f32 v84, v84
    v_rcp_f32 v85, v85
    v_rcp_f32 v86, v86
    v_rcp_f32 v87, v87
    v_rcp_f32 v88, v88
    v_rcp_f32 v89, v89
    v_rcp_f32 v90, v90
    v_rcp_f32 v91, v91
    v_mul_f32 v56, v56, v84
    v_mul_f32 v57, v57, v85
    v_mul_f32 v58, v58, v86
    v_mul_f32 v59, v59, v87
    v_mul_f32 v60, v60, v88
    v_mul_f32 v61, v61, v89
    v_mul_f32 v62, v62, v90
    v_mul_f32 v63, v63, v91
    v_cvt_pk_bf16_f32 v80, v56, v57
    v_cvt_pk_bf16_f32 v81, v58, v59
    v_cvt_pk_bf16_f32 v82, v60, v61
    v_cvt_pk_bf16_f32 v83, v62, v63
    ds_write_b64 v112, v[80:81] offset:96
    ds_write_b64 v112, v[82:83] offset:112
    v_cvt_pk_bf16_f32 v80, v64, v65
    v_cvt_pk_bf16_f32 v81, v66, v67
    v_cvt_pk_bf16_f32 v82, v68, v69
    v_cvt_pk_bf16_f32 v83, v70, v71
    v_lshlrev_b32 v64, 16, v80
    v_and_b32 v65, 0xffff0000, v80
    v_lshlrev_b32 v66, 16, v81
    v_and_b32 v67, 0xffff0000, v81
    v_lshlrev_b32 v68, 16, v82
    v_and_b32 v69, 0xffff0000, v82
    v_lshlrev_b32 v70, 16, v83
    v_and_b32 v71, 0xffff0000, v83
    v_mul_f32 v84, 0xbfb8aa3b, v64
    v_mul_f32 v85, 0xbfb8aa3b, v65
    v_mul_f32 v86, 0xbfb8aa3b, v66
    v_mul_f32 v87, 0xbfb8aa3b, v67
    v_mul_f32 v88, 0xbfb8aa3b, v68
    v_mul_f32 v89, 0xbfb8aa3b, v69
    v_mul_f32 v90, 0xbfb8aa3b, v70
    v_mul_f32 v91, 0xbfb8aa3b, v71
    v_exp_f32 v84, v84
    v_exp_f32 v85, v85
    v_exp_f32 v86, v86
    v_exp_f32 v87, v87
    v_exp_f32 v88, v88
    v_exp_f32 v89, v89
    v_exp_f32 v90, v90
    v_exp_f32 v91, v91
    v_add_f32 v84, 1.0, v84
    v_add_f32 v85, 1.0, v85
    v_add_f32 v86, 1.0, v86
    v_add_f32 v87, 1.0, v87
    v_add_f32 v88, 1.0, v88
    v_add_f32 v89, 1.0, v89
    v_add_f32 v90, 1.0, v90
    v_add_f32 v91, 1.0, v91
    v_rcp_f32 v84, v84
    v_rcp_f32 v85, v85
    v_rcp_f32 v86, v86
    v_rcp_f32 v87, v87
    v_rcp_f32 v88, v88
    v_rcp_f32 v89, v89
    v_rcp_f32 v90, v90
    v_rcp_f32 v91, v91
    v_mul_f32 v64, v64, v84
    v_mul_f32 v65, v65, v85
    v_mul_f32 v66, v66, v86
    v_mul_f32 v67, v67, v87
    v_mul_f32 v68, v68, v88
    v_mul_f32 v69, v69, v89
    v_mul_f32 v70, v70, v90
    v_mul_f32 v71, v71, v91
    v_cvt_pk_bf16_f32 v80, v64, v65
    v_cvt_pk_bf16_f32 v81, v66, v67
    v_cvt_pk_bf16_f32 v82, v68, v69
    v_cvt_pk_bf16_f32 v83, v70, v71
    ds_write_b64 v112, v[80:81] offset:4672
    ds_write_b64 v112, v[82:83] offset:4688
    v_cvt_pk_bf16_f32 v80, v72, v73
    v_cvt_pk_bf16_f32 v81, v74, v75
    v_cvt_pk_bf16_f32 v82, v76, v77
    v_cvt_pk_bf16_f32 v83, v78, v79
    v_lshlrev_b32 v72, 16, v80
    v_and_b32 v73, 0xffff0000, v80
    v_lshlrev_b32 v74, 16, v81
    v_and_b32 v75, 0xffff0000, v81
    v_lshlrev_b32 v76, 16, v82
    v_and_b32 v77, 0xffff0000, v82
    v_lshlrev_b32 v78, 16, v83
    v_and_b32 v79, 0xffff0000, v83
    v_mul_f32 v84, 0xbfb8aa3b, v72
    v_mul_f32 v85, 0xbfb8aa3b, v73
    v_mul_f32 v86, 0xbfb8aa3b, v74
    v_mul_f32 v87, 0xbfb8aa3b, v75
    v_mul_f32 v88, 0xbfb8aa3b, v76
    v_mul_f32 v89, 0xbfb8aa3b, v77
    v_mul_f32 v90, 0xbfb8aa3b, v78
    v_mul_f32 v91, 0xbfb8aa3b, v79
    v_exp_f32 v84, v84
    v_exp_f32 v85, v85
    v_exp_f32 v86, v86
    v_exp_f32 v87, v87
    v_exp_f32 v88, v88
    v_exp_f32 v89, v89
    v_exp_f32 v90, v90
    v_exp_f32 v91, v91
    v_add_f32 v84, 1.0, v84
    v_add_f32 v85, 1.0, v85
    v_add_f32 v86, 1.0, v86
    v_add_f32 v87, 1.0, v87
    v_add_f32 v88, 1.0, v88
    v_add_f32 v89, 1.0, v89
    v_add_f32 v90, 1.0, v90
    v_add_f32 v91, 1.0, v91
    v_rcp_f32 v84, v84
    v_rcp_f32 v85, v85
    v_rcp_f32 v86, v86
    v_rcp_f32 v87, v87
    v_rcp_f32 v88, v88
    v_rcp_f32 v89, v89
    v_rcp_f32 v90, v90
    v_rcp_f32 v91, v91
    v_mul_f32 v72, v72, v84
    v_mul_f32 v73, v73, v85
    v_mul_f32 v74, v74, v86
    v_mul_f32 v75, v75, v87
    v_mul_f32 v76, v76, v88
    v_mul_f32 v77, v77, v89
    v_mul_f32 v78, v78, v90
    v_mul_f32 v79, v79, v91
    v_cvt_pk_bf16_f32 v80, v72, v73
    v_cvt_pk_bf16_f32 v81, v74, v75
    v_cvt_pk_bf16_f32 v82, v76, v77
    v_cvt_pk_bf16_f32 v83, v78, v79
    ds_write_b64 v112, v[80:81] offset:4704
    ds_write_b64 v112, v[82:83] offset:4720
    s_waitcnt lgkmcnt(0)
    ds_read_b128 v[16:19], v113 offset:0
    ds_read_b128 v[20:23], v113 offset:1152
    ds_read_b128 v[24:27], v113 offset:2304
    ds_read_b128 v[28:31], v113 offset:3456
    ds_read_b128 v[32:35], v113 offset:4608
    ds_read_b128 v[36:39], v113 offset:5760
    ds_read_b128 v[40:43], v113 offset:6912
    ds_read_b128 v[44:47], v113 offset:8064
    s_mov_b32 s23, 0
    s_waitcnt lgkmcnt(7)
    buffer_store_dwordx4 v[16:19], v114, s[12:15], s23 offen
    s_add_u32 s23, s23, 27648
    s_waitcnt lgkmcnt(6)
    buffer_store_dwordx4 v[20:23], v114, s[12:15], s23 offen
    s_add_u32 s23, s23, 27648
    s_waitcnt lgkmcnt(5)
    buffer_store_dwordx4 v[24:27], v114, s[12:15], s23 offen
    s_add_u32 s23, s23, 27648
    s_waitcnt lgkmcnt(4)
    buffer_store_dwordx4 v[28:31], v114, s[12:15], s23 offen
    s_add_u32 s23, s23, 27648
    s_waitcnt lgkmcnt(3)
    buffer_store_dwordx4 v[32:35], v114, s[12:15], s23 offen
    s_add_u32 s23, s23, 27648
    s_waitcnt lgkmcnt(2)
    buffer_store_dwordx4 v[36:39], v114, s[12:15], s23 offen
    s_add_u32 s23, s23, 27648
    s_waitcnt lgkmcnt(1)
    buffer_store_dwordx4 v[40:43], v114, s[12:15], s23 offen
    s_add_u32 s23, s23, 27648
    s_waitcnt lgkmcnt(0)
    buffer_store_dwordx4 v[44:47], v114, s[12:15], s23 offen
g1skip_1:
    s_endpgm
L_end_k1_kernel:
    s_endpgm
.globl gemm2_kernel
.p2align 8
.type gemm2_kernel,@function
gemm2_kernel:
    s_cmp_ge_u32 s2, 160
    s_cbranch_scc1 L_end_gemm2_kernel
    s_load_dwordx2 s[20:21], s[0:1], 104
    s_load_dwordx2 s[22:23], s[0:1], 72
    s_load_dwordx2 s[24:25], s[0:1], 88
    s_waitcnt lgkmcnt(0)
    s_mov_b32 s4, s20
    s_mov_b32 s5, s21
    s_mov_b32 s6, 0x6c0000
    s_mov_b32 s7, 0x00020000
    s_mov_b32 s8, s22
    s_mov_b32 s9, s23
    s_mov_b32 s10, 0x21c000
    s_mov_b32 s11, 0x00020000
    s_mov_b32 s12, s24
    s_mov_b32 s13, s25
    s_mov_b32 s14, 0x280000
    s_mov_b32 s15, 0x00020000
    s_mov_b32 s16, s20
    s_mov_b32 s17, s21
    s_mov_b32 s18, 0xc02000
    s_mov_b32 s19, 0x00020000
    s_lshr_b32 s28, s2, 3
    s_cmp_ge_u32 s28, 10
    s_cselect_b32 s26, 1, 0
    s_mul_i32 s27, s26, 10
    s_sub_u32 s27, s28, s27
    s_and_b32 s28, s2, 7
    s_lshl_b32 s28, s28, 1
    s_add_u32 s26, s26, s28
    s_lshl_b32 s28, s26, 7
    s_lshl_b32 s29, s27, 6
    v_add_u32 v24, 0, v0
    v_lshrrev_b32 v25, 4, v24
    v_and_b32 v26, 15, v24
    v_add_u32 v27, s29, v25
    v_lshlrev_b32 v27, 12, v27
    v_lshl_add_u32 v27, v26, 4, v27
    s_lshl_b32 s26, s28, 1
    s_add_u32 s26, s26, 0x800000
    buffer_load_dwordx4 v[4:7], v27, s[16:19], s26 offen
    s_mov_b32 s27, 272
    v_mul_lo_u32 v28, v25, s27
    v_lshl_add_u32 v20, v26, 4, v28
    v_add_u32 v24, 256, v0
    v_lshrrev_b32 v25, 4, v24
    v_and_b32 v26, 15, v24
    v_add_u32 v27, s29, v25
    v_lshlrev_b32 v27, 12, v27
    v_lshl_add_u32 v27, v26, 4, v27
    s_lshl_b32 s26, s28, 1
    s_add_u32 s26, s26, 0x800000
    buffer_load_dwordx4 v[8:11], v27, s[16:19], s26 offen
    s_mov_b32 s27, 272
    v_mul_lo_u32 v28, v25, s27
    v_lshl_add_u32 v21, v26, 4, v28
    v_add_u32 v24, 512, v0
    v_lshrrev_b32 v25, 4, v24
    v_and_b32 v26, 15, v24
    v_add_u32 v27, s29, v25
    v_lshlrev_b32 v27, 12, v27
    v_lshl_add_u32 v27, v26, 4, v27
    s_lshl_b32 s26, s28, 1
    s_add_u32 s26, s26, 0x800000
    buffer_load_dwordx4 v[12:15], v27, s[16:19], s26 offen
    s_mov_b32 s27, 272
    v_mul_lo_u32 v28, v25, s27
    v_lshl_add_u32 v22, v26, 4, v28
    v_add_u32 v24, 768, v0
    v_lshrrev_b32 v25, 4, v24
    v_and_b32 v26, 15, v24
    v_add_u32 v27, s29, v25
    v_lshlrev_b32 v27, 12, v27
    v_lshl_add_u32 v27, v26, 4, v27
    s_lshl_b32 s26, s28, 1
    s_add_u32 s26, s26, 0x800000
    buffer_load_dwordx4 v[16:19], v27, s[16:19], s26 offen
    s_mov_b32 s27, 272
    v_mul_lo_u32 v28, v25, s27
    v_lshl_add_u32 v23, v26, 4, v28
    v_and_b32 v24, 63, v0
    v_lshrrev_b32 v25, 6, v0
    s_nop 0
    v_readfirstlane_b32 s30, v25
    s_nop 4
    s_lshr_b32 s31, s30, 1
    s_and_b32 s32, s30, 1
    s_mul_i32 s33, s30, 256
    s_add_u32 s33, s33, 0
    v_add_u32 v25, s33, v24
    v_lshrrev_b32 v26, 3, v25
    v_and_b32 v25, 7, v25
    v_lshrrev_b32 v27, 1, v26
    v_and_b32 v27, 7, v27
    v_xor_b32 v25, v25, v27
    v_add_u32 v26, s28, v26
    s_mov_b32 s34, 3456
    v_mul_lo_u32 v26, v26, s34
    v_lshl_add_u32 v28, v25, 4, v26
    s_mul_i32 s33, s30, 256
    s_add_u32 s33, s33, 64
    v_add_u32 v25, s33, v24
    v_lshrrev_b32 v26, 3, v25
    v_and_b32 v25, 7, v25
    v_lshrrev_b32 v27, 1, v26
    v_and_b32 v27, 7, v27
    v_xor_b32 v25, v25, v27
    v_add_u32 v26, s28, v26
    s_mov_b32 s34, 3456
    v_mul_lo_u32 v26, v26, s34
    v_lshl_add_u32 v29, v25, 4, v26
    s_mul_i32 s33, s30, 256
    s_add_u32 s33, s33, 128
    v_add_u32 v25, s33, v24
    v_lshrrev_b32 v26, 3, v25
    v_and_b32 v25, 7, v25
    v_lshrrev_b32 v27, 1, v26
    v_and_b32 v27, 7, v27
    v_xor_b32 v25, v25, v27
    v_add_u32 v26, s28, v26
    s_mov_b32 s34, 3456
    v_mul_lo_u32 v26, v26, s34
    v_lshl_add_u32 v30, v25, 4, v26
    s_mul_i32 s33, s30, 256
    s_add_u32 s33, s33, 192
    v_add_u32 v25, s33, v24
    v_lshrrev_b32 v26, 3, v25
    v_and_b32 v25, 7, v25
    v_lshrrev_b32 v27, 1, v26
    v_and_b32 v27, 7, v27
    v_xor_b32 v25, v25, v27
    v_add_u32 v26, s28, v26
    s_mov_b32 s34, 3456
    v_mul_lo_u32 v26, v26, s34
    v_lshl_add_u32 v31, v25, 4, v26
    s_mul_i32 s33, s30, 128
    s_add_u32 s33, s33, 0
    v_add_u32 v25, s33, v24
    v_lshrrev_b32 v26, 3, v25
    v_and_b32 v25, 7, v25
    v_lshrrev_b32 v27, 1, v26
    v_and_b32 v27, 1, v27
    v_lshlrev_b32 v27, 2, v27
    v_xor_b32 v25, v25, v27
    s_mov_b32 s34, 1280
    v_mul_lo_u32 v26, v26, s34
    v_lshl_add_u32 v25, v25, 4, v26
    s_lshl_b32 s34, s29, 1
    v_add_u32 v32, s34, v25
    s_mul_i32 s33, s30, 128
    s_add_u32 s33, s33, 64
    v_add_u32 v25, s33, v24
    v_lshrrev_b32 v26, 3, v25
    v_and_b32 v25, 7, v25
    v_lshrrev_b32 v27, 1, v26
    v_and_b32 v27, 1, v27
    v_lshlrev_b32 v27, 2, v27
    v_xor_b32 v25, v25, v27
    s_mov_b32 s34, 1280
    v_mul_lo_u32 v26, v26, s34
    v_lshl_add_u32 v25, v25, 4, v26
    s_lshl_b32 s34, s29, 1
    v_add_u32 v33, s34, v25
    s_mul_i32 s35, s30, 4096
    s_mul_i32 s36, s30, 2048
    v_and_b32 v25, 31, v24
    v_lshrrev_b32 v26, 5, v24
    s_mul_i32 s33, s31, 64
    s_add_u32 s33, s33, 0
    v_add_u32 v27, s33, v25
    v_lshrrev_b32 v42, 1, v27
    v_and_b32 v42, 7, v42
    v_add_u32 v34, 0, v26
    v_xor_b32 v34, v34, v42
    v_lshlrev_b32 v34, 4, v34
    v_lshl_add_u32 v34, v27, 7, v34
    v_add_u32 v35, 2, v26
    v_xor_b32 v35, v35, v42
    v_lshlrev_b32 v35, 4, v35
    v_lshl_add_u32 v35, v27, 7, v35
    v_add_u32 v36, 4, v26
    v_xor_b32 v36, v36, v42
    v_lshlrev_b32 v36, 4, v36
    v_lshl_add_u32 v36, v27, 7, v36
    v_add_u32 v37, 6, v26
    v_xor_b32 v37, v37, v42
    v_lshlrev_b32 v37, 4, v37
    v_lshl_add_u32 v37, v27, 7, v37
    s_mul_i32 s33, s31, 64
    s_add_u32 s33, s33, 32
    v_add_u32 v27, s33, v25
    v_lshrrev_b32 v42, 1, v27
    v_and_b32 v42, 7, v42
    v_add_u32 v38, 0, v26
    v_xor_b32 v38, v38, v42
    v_lshlrev_b32 v38, 4, v38
    v_lshl_add_u32 v38, v27, 7, v38
    v_add_u32 v39, 2, v26
    v_xor_b32 v39, v39, v42
    v_lshlrev_b32 v39, 4, v39
    v_lshl_add_u32 v39, v27, 7, v39
    v_add_u32 v40, 4, v26
    v_xor_b32 v40, v40, v42
    v_lshlrev_b32 v40, 4, v40
    v_lshl_add_u32 v40, v27, 7, v40
    v_add_u32 v41, 6, v26
    v_xor_b32 v41, v41, v42
    v_lshlrev_b32 v41, 4, v41
    v_lshl_add_u32 v41, v27, 7, v41
    v_add_u32 v42, 0x10000, v34
    v_add_u32 v43, 0x10000, v35
    v_add_u32 v44, 0x10000, v36
    v_add_u32 v45, 0x10000, v37
    v_add_u32 v46, 0x10000, v38
    v_add_u32 v47, 0x10000, v39
    v_add_u32 v48, 0x10000, v40
    v_add_u32 v49, 0x10000, v41
    v_lshrrev_b32 v51, 2, v24
    v_and_b32 v51, 3, v51
    v_lshrrev_b32 v52, 5, v24
    v_lshl_add_u32 v52, v52, 3, v51
    v_lshrrev_b32 v25, 4, v24
    v_and_b32 v25, 1, v25
    v_lshlrev_b32 v25, 5, v25
    v_and_b32 v26, 3, v24
    v_lshl_add_u32 v25, v26, 3, v25
    s_mul_i32 s33, s32, 64
    s_add_u32 s33, s33, 0
    v_add_u32 v25, s33, v25
    v_lshrrev_b32 v26, 1, v51
    v_lshlrev_b32 v26, 6, v26
    v_xor_b32 v25, v25, v26
    v_lshl_add_u32 v50, v52, 7, v25
    v_add_u32 v50, 98304, v50
    v_mov_b32 v56, 0
    v_mov_b32 v57, 0
    v_mov_b32 v58, 0
    v_mov_b32 v59, 0
    v_mov_b32 v60, 0
    v_mov_b32 v61, 0
    v_mov_b32 v62, 0
    v_mov_b32 v63, 0
    v_mov_b32 v64, 0
    v_mov_b32 v65, 0
    v_mov_b32 v66, 0
    v_mov_b32 v67, 0
    v_mov_b32 v68, 0
    v_mov_b32 v69, 0
    v_mov_b32 v70, 0
    v_mov_b32 v71, 0
    v_mov_b32 v72, 0
    v_mov_b32 v73, 0
    v_mov_b32 v74, 0
    v_mov_b32 v75, 0
    v_mov_b32 v76, 0
    v_mov_b32 v77, 0
    v_mov_b32 v78, 0
    v_mov_b32 v79, 0
    v_mov_b32 v80, 0
    v_mov_b32 v81, 0
    v_mov_b32 v82, 0
    v_mov_b32 v83, 0
    v_mov_b32 v84, 0
    v_mov_b32 v85, 0
    v_mov_b32 v86, 0
    v_mov_b32 v87, 0
    s_mov_b32 s37, 0
    s_mov_b32 s38, 0
    s_add_u32 m0, s35, 0
    s_nop 0
    buffer_load_dwordx4 v28, s[4:7], s37 offen lds
    s_add_u32 m0, s35, 1024
    s_nop 0
    buffer_load_dwordx4 v29, s[4:7], s37 offen lds
    s_add_u32 m0, s35, 2048
    s_nop 0
    buffer_load_dwordx4 v30, s[4:7], s37 offen lds
    s_add_u32 m0, s35, 3072
    s_nop 0
    buffer_load_dwordx4 v31, s[4:7], s37 offen lds
    s_add_u32 m0, s36, 98304
    s_nop 0
    buffer_load_dwordx4 v32, s[8:11], s38 offen lds
    s_add_u32 m0, s36, 99328
    s_nop 0
    buffer_load_dwordx4 v33, s[8:11], s38 offen lds
    s_mov_b32 s37, 128
    s_mov_b32 s38, 81920
    s_add_u32 m0, s35, 16384
    s_nop 0
    buffer_load_dwordx4 v28, s[4:7], s37 offen lds
    s_add_u32 m0, s35, 17408
    s_nop 0
    buffer_load_dwordx4 v29, s[4:7], s37 offen lds
    s_add_u32 m0, s35, 18432
    s_nop 0
    buffer_load_dwordx4 v30, s[4:7], s37 offen lds
    s_add_u32 m0, s35, 19456
    s_nop 0
    buffer_load_dwordx4 v31, s[4:7], s37 offen lds
    s_add_u32 m0, s36, 106496
    s_nop 0
    buffer_load_dwordx4 v32, s[8:11], s38 offen lds
    s_add_u32 m0, s36, 107520
    s_nop 0
    buffer_load_dwordx4 v33, s[8:11], s38 offen lds
    s_mov_b32 s37, 256
    s_mov_b32 s38, 163840
    s_add_u32 m0, s35, 32768
    s_nop 0
    buffer_load_dwordx4 v28, s[4:7], s37 offen lds
    s_add_u32 m0, s35, 33792
    s_nop 0
    buffer_load_dwordx4 v29, s[4:7], s37 offen lds
    s_add_u32 m0, s35, 34816
    s_nop 0
    buffer_load_dwordx4 v30, s[4:7], s37 offen lds
    s_add_u32 m0, s35, 35840
    s_nop 0
    buffer_load_dwordx4 v31, s[4:7], s37 offen lds
    s_add_u32 m0, s36, 114688
    s_nop 0
    buffer_load_dwordx4 v32, s[8:11], s38 offen lds
    s_add_u32 m0, s36, 115712
    s_nop 0
    buffer_load_dwordx4 v33, s[8:11], s38 offen lds
    s_mov_b32 s37, 384
    s_mov_b32 s38, 245760
    s_add_u32 m0, s35, 49152
    s_nop 0
    buffer_load_dwordx4 v28, s[4:7], s37 offen lds
    s_add_u32 m0, s35, 50176
    s_nop 0
    buffer_load_dwordx4 v29, s[4:7], s37 offen lds
    s_add_u32 m0, s35, 51200
    s_nop 0
    buffer_load_dwordx4 v30, s[4:7], s37 offen lds
    s_add_u32 m0, s35, 52224
    s_nop 0
    buffer_load_dwordx4 v31, s[4:7], s37 offen lds
    s_add_u32 m0, s36, 122880
    s_nop 0
    buffer_load_dwordx4 v32, s[8:11], s38 offen lds
    s_add_u32 m0, s36, 123904
    s_nop 0
    buffer_load_dwordx4 v33, s[8:11], s38 offen lds
    s_mov_b32 s37, 512
    s_mov_b32 s38, 327680
    s_add_u32 m0, s35, 65536
    s_nop 0
    buffer_load_dwordx4 v28, s[4:7], s37 offen lds
    s_add_u32 m0, s35, 66560
    s_nop 0
    buffer_load_dwordx4 v29, s[4:7], s37 offen lds
    s_add_u32 m0, s35, 67584
    s_nop 0
    buffer_load_dwordx4 v30, s[4:7], s37 offen lds
    s_add_u32 m0, s35, 68608
    s_nop 0
    buffer_load_dwordx4 v31, s[4:7], s37 offen lds
    s_add_u32 m0, s36, 131072
    s_nop 0
    buffer_load_dwordx4 v32, s[8:11], s38 offen lds
    s_add_u32 m0, s36, 132096
    s_nop 0
    buffer_load_dwordx4 v33, s[8:11], s38 offen lds
    s_waitcnt vmcnt(24)
    s_barrier
    s_mov_b32 s37, 640
    s_mov_b32 s38, 409600
    s_add_u32 m0, s35, 81920
    s_nop 0
    buffer_load_dwordx4 v28, s[4:7], s37 offen lds
    s_add_u32 m0, s35, 82944
    s_nop 0
    buffer_load_dwordx4 v29, s[4:7], s37 offen lds
    s_add_u32 m0, s35, 83968
    s_nop 0
    buffer_load_dwordx4 v30, s[4:7], s37 offen lds
    s_add_u32 m0, s35, 84992
    s_nop 0
    buffer_load_dwordx4 v31, s[4:7], s37 offen lds
    s_add_u32 m0, s36, 139264
    s_nop 0
    buffer_load_dwordx4 v32, s[8:11], s38 offen lds
    s_add_u32 m0, s36, 140288
    s_nop 0
    buffer_load_dwordx4 v33, s[8:11], s38 offen lds
    ds_read_b128 v[88:91], v34 offset:0
    ds_read_b128 v[92:95], v38 offset:0
    ds_read_b64_tr_b16 v[104:105], v50 offset:0
    ds_read_b64_tr_b16 v[106:107], v50 offset:512
    ds_read_b128 v[96:99], v35 offset:0
    ds_read_b128 v[100:103], v39 offset:0
    ds_read_b64_tr_b16 v[108:109], v50 offset:2048
    ds_read_b64_tr_b16 v[110:111], v50 offset:2560
    s_waitcnt lgkmcnt(4)
    v_mfma_f32_32x32x16_bf16 v[56:71], v[104:107], v[88:91], v[56:71]
    v_mfma_f32_32x32x16_bf16 v[72:87], v[104:107], v[92:95], v[72:87]
    ds_read_b128 v[88:91], v36 offset:0
    ds_read_b128 v[92:95], v40 offset:0
    ds_read_b64_tr_b16 v[104:105], v50 offset:4096
    ds_read_b64_tr_b16 v[106:107], v50 offset:4608
    s_waitcnt lgkmcnt(4)
    v_mfma_f32_32x32x16_bf16 v[56:71], v[108:111], v[96:99], v[56:71]
    v_mfma_f32_32x32x16_bf16 v[72:87], v[108:111], v[100:103], v[72:87]
    ds_read_b128 v[96:99], v37 offset:0
    ds_read_b128 v[100:103], v41 offset:0
    ds_read_b64_tr_b16 v[108:109], v50 offset:6144
    ds_read_b64_tr_b16 v[110:111], v50 offset:6656
    s_waitcnt lgkmcnt(4)
    v_mfma_f32_32x32x16_bf16 v[56:71], v[104:107], v[88:91], v[56:71]
    v_mfma_f32_32x32x16_bf16 v[72:87], v[104:107], v[92:95], v[72:87]
    s_waitcnt lgkmcnt(0)
    v_mfma_f32_32x32x16_bf16 v[56:71], v[108:111], v[96:99], v[56:71]
    v_mfma_f32_32x32x16_bf16 v[72:87], v[108:111], v[100:103], v[72:87]
    s_waitcnt vmcnt(24)
    s_barrier
    s_mov_b32 s37, 768
    s_mov_b32 s38, 491520
    s_add_u32 m0, s35, 0
    s_nop 0
    buffer_load_dwordx4 v28, s[4:7], s37 offen lds
    s_add_u32 m0, s35, 1024
    s_nop 0
    buffer_load_dwordx4 v29, s[4:7], s37 offen lds
    s_add_u32 m0, s35, 2048
    s_nop 0
    buffer_load_dwordx4 v30, s[4:7], s37 offen lds
    s_add_u32 m0, s35, 3072
    s_nop 0
    buffer_load_dwordx4 v31, s[4:7], s37 offen lds
    s_add_u32 m0, s36, 98304
    s_nop 0
    buffer_load_dwordx4 v32, s[8:11], s38 offen lds
    s_add_u32 m0, s36, 99328
    s_nop 0
    buffer_load_dwordx4 v33, s[8:11], s38 offen lds
    ds_read_b128 v[88:91], v34 offset:16384
    ds_read_b128 v[92:95], v38 offset:16384
    ds_read_b64_tr_b16 v[104:105], v50 offset:8192
    ds_read_b64_tr_b16 v[106:107], v50 offset:8704
    ds_read_b128 v[96:99], v35 offset:16384
    ds_read_b128 v[100:103], v39 offset:16384
    ds_read_b64_tr_b16 v[108:109], v50 offset:10240
    ds_read_b64_tr_b16 v[110:111], v50 offset:10752
    s_waitcnt lgkmcnt(4)
    v_mfma_f32_32x32x16_bf16 v[56:71], v[104:107], v[88:91], v[56:71]
    v_mfma_f32_32x32x16_bf16 v[72:87], v[104:107], v[92:95], v[72:87]
    ds_read_b128 v[88:91], v36 offset:16384
    ds_read_b128 v[92:95], v40 offset:16384
    ds_read_b64_tr_b16 v[104:105], v50 offset:12288
    ds_read_b64_tr_b16 v[106:107], v50 offset:12800
    s_waitcnt lgkmcnt(4)
    v_mfma_f32_32x32x16_bf16 v[56:71], v[108:111], v[96:99], v[56:71]
    v_mfma_f32_32x32x16_bf16 v[72:87], v[108:111], v[100:103], v[72:87]
    ds_read_b128 v[96:99], v37 offset:16384
    ds_read_b128 v[100:103], v41 offset:16384
    ds_read_b64_tr_b16 v[108:109], v50 offset:14336
    ds_read_b64_tr_b16 v[110:111], v50 offset:14848
    s_waitcnt lgkmcnt(4)
    v_mfma_f32_32x32x16_bf16 v[56:71], v[104:107], v[88:91], v[56:71]
    v_mfma_f32_32x32x16_bf16 v[72:87], v[104:107], v[92:95], v[72:87]
    s_waitcnt lgkmcnt(0)
    v_mfma_f32_32x32x16_bf16 v[56:71], v[108:111], v[96:99], v[56:71]
    v_mfma_f32_32x32x16_bf16 v[72:87], v[108:111], v[100:103], v[72:87]
    s_waitcnt vmcnt(24)
    s_barrier
    s_mov_b32 s37, 896
    s_mov_b32 s38, 573440
    s_add_u32 m0, s35, 16384
    s_nop 0
    buffer_load_dwordx4 v28, s[4:7], s37 offen lds
    s_add_u32 m0, s35, 17408
    s_nop 0
    buffer_load_dwordx4 v29, s[4:7], s37 offen lds
    s_add_u32 m0, s35, 18432
    s_nop 0
    buffer_load_dwordx4 v30, s[4:7], s37 offen lds
    s_add_u32 m0, s35, 19456
    s_nop 0
    buffer_load_dwordx4 v31, s[4:7], s37 offen lds
    s_add_u32 m0, s36, 106496
    s_nop 0
    buffer_load_dwordx4 v32, s[8:11], s38 offen lds
    s_add_u32 m0, s36, 107520
    s_nop 0
    buffer_load_dwordx4 v33, s[8:11], s38 offen lds
    ds_read_b128 v[88:91], v34 offset:32768
    ds_read_b128 v[92:95], v38 offset:32768
    ds_read_b64_tr_b16 v[104:105], v50 offset:16384
    ds_read_b64_tr_b16 v[106:107], v50 offset:16896
    ds_read_b128 v[96:99], v35 offset:32768
    ds_read_b128 v[100:103], v39 offset:32768
    ds_read_b64_tr_b16 v[108:109], v50 offset:18432
    ds_read_b64_tr_b16 v[110:111], v50 offset:18944
    s_waitcnt lgkmcnt(4)
    v_mfma_f32_32x32x16_bf16 v[56:71], v[104:107], v[88:91], v[56:71]
    v_mfma_f32_32x32x16_bf16 v[72:87], v[104:107], v[92:95], v[72:87]
    ds_read_b128 v[88:91], v36 offset:32768
    ds_read_b128 v[92:95], v40 offset:32768
    ds_read_b64_tr_b16 v[104:105], v50 offset:20480
    ds_read_b64_tr_b16 v[106:107], v50 offset:20992
    s_waitcnt lgkmcnt(4)
    v_mfma_f32_32x32x16_bf16 v[56:71], v[108:111], v[96:99], v[56:71]
    v_mfma_f32_32x32x16_bf16 v[72:87], v[108:111], v[100:103], v[72:87]
    ds_read_b128 v[96:99], v37 offset:32768
    ds_read_b128 v[100:103], v41 offset:32768
    ds_read_b64_tr_b16 v[108:109], v50 offset:22528
    ds_read_b64_tr_b16 v[110:111], v50 offset:23040
    s_waitcnt lgkmcnt(4)
    v_mfma_f32_32x32x16_bf16 v[56:71], v[104:107], v[88:91], v[56:71]
    v_mfma_f32_32x32x16_bf16 v[72:87], v[104:107], v[92:95], v[72:87]
    s_waitcnt lgkmcnt(0)
    v_mfma_f32_32x32x16_bf16 v[56:71], v[108:111], v[96:99], v[56:71]
    v_mfma_f32_32x32x16_bf16 v[72:87], v[108:111], v[100:103], v[72:87]
    s_waitcnt vmcnt(24)
    s_barrier
    s_mov_b32 s37, 1024
    s_mov_b32 s38, 655360
    s_add_u32 m0, s35, 32768
    s_nop 0
    buffer_load_dwordx4 v28, s[4:7], s37 offen lds
    s_add_u32 m0, s35, 33792
    s_nop 0
    buffer_load_dwordx4 v29, s[4:7], s37 offen lds
    s_add_u32 m0, s35, 34816
    s_nop 0
    buffer_load_dwordx4 v30, s[4:7], s37 offen lds
    s_add_u32 m0, s35, 35840
    s_nop 0
    buffer_load_dwordx4 v31, s[4:7], s37 offen lds
    s_add_u32 m0, s36, 114688
    s_nop 0
    buffer_load_dwordx4 v32, s[8:11], s38 offen lds
    s_add_u32 m0, s36, 115712
    s_nop 0
    buffer_load_dwordx4 v33, s[8:11], s38 offen lds
    ds_read_b128 v[88:91], v34 offset:49152
    ds_read_b128 v[92:95], v38 offset:49152
    ds_read_b64_tr_b16 v[104:105], v50 offset:24576
    ds_read_b64_tr_b16 v[106:107], v50 offset:25088
    ds_read_b128 v[96:99], v35 offset:49152
    ds_read_b128 v[100:103], v39 offset:49152
    ds_read_b64_tr_b16 v[108:109], v50 offset:26624
    ds_read_b64_tr_b16 v[110:111], v50 offset:27136
    s_waitcnt lgkmcnt(4)
    v_mfma_f32_32x32x16_bf16 v[56:71], v[104:107], v[88:91], v[56:71]
    v_mfma_f32_32x32x16_bf16 v[72:87], v[104:107], v[92:95], v[72:87]
    ds_read_b128 v[88:91], v36 offset:49152
    ds_read_b128 v[92:95], v40 offset:49152
    ds_read_b64_tr_b16 v[104:105], v50 offset:28672
    ds_read_b64_tr_b16 v[106:107], v50 offset:29184
    s_waitcnt lgkmcnt(4)
    v_mfma_f32_32x32x16_bf16 v[56:71], v[108:111], v[96:99], v[56:71]
    v_mfma_f32_32x32x16_bf16 v[72:87], v[108:111], v[100:103], v[72:87]
    ds_read_b128 v[96:99], v37 offset:49152
    ds_read_b128 v[100:103], v41 offset:49152
    ds_read_b64_tr_b16 v[108:109], v50 offset:30720
    ds_read_b64_tr_b16 v[110:111], v50 offset:31232
    s_waitcnt lgkmcnt(4)
    v_mfma_f32_32x32x16_bf16 v[56:71], v[104:107], v[88:91], v[56:71]
    v_mfma_f32_32x32x16_bf16 v[72:87], v[104:107], v[92:95], v[72:87]
    s_waitcnt lgkmcnt(0)
    v_mfma_f32_32x32x16_bf16 v[56:71], v[108:111], v[96:99], v[56:71]
    v_mfma_f32_32x32x16_bf16 v[72:87], v[108:111], v[100:103], v[72:87]
    s_waitcnt vmcnt(24)
    s_barrier
    s_mov_b32 s37, 1152
    s_mov_b32 s38, 737280
    s_add_u32 m0, s35, 49152
    s_nop 0
    buffer_load_dwordx4 v28, s[4:7], s37 offen lds
    s_add_u32 m0, s35, 50176
    s_nop 0
    buffer_load_dwordx4 v29, s[4:7], s37 offen lds
    s_add_u32 m0, s35, 51200
    s_nop 0
    buffer_load_dwordx4 v30, s[4:7], s37 offen lds
    s_add_u32 m0, s35, 52224
    s_nop 0
    buffer_load_dwordx4 v31, s[4:7], s37 offen lds
    s_add_u32 m0, s36, 122880
    s_nop 0
    buffer_load_dwordx4 v32, s[8:11], s38 offen lds
    s_add_u32 m0, s36, 123904
    s_nop 0
    buffer_load_dwordx4 v33, s[8:11], s38 offen lds
    ds_read_b128 v[88:91], v42 offset:0
    ds_read_b128 v[92:95], v46 offset:0
    ds_read_b64_tr_b16 v[104:105], v50 offset:32768
    ds_read_b64_tr_b16 v[106:107], v50 offset:33280
    ds_read_b128 v[96:99], v43 offset:0
    ds_read_b128 v[100:103], v47 offset:0
    ds_read_b64_tr_b16 v[108:109], v50 offset:34816
    ds_read_b64_tr_b16 v[110:111], v50 offset:35328
    s_waitcnt lgkmcnt(4)
    v_mfma_f32_32x32x16_bf16 v[56:71], v[104:107], v[88:91], v[56:71]
    v_mfma_f32_32x32x16_bf16 v[72:87], v[104:107], v[92:95], v[72:87]
    ds_read_b128 v[88:91], v44 offset:0
    ds_read_b128 v[92:95], v48 offset:0
    ds_read_b64_tr_b16 v[104:105], v50 offset:36864
    ds_read_b64_tr_b16 v[106:107], v50 offset:37376
    s_waitcnt lgkmcnt(4)
    v_mfma_f32_32x32x16_bf16 v[56:71], v[108:111], v[96:99], v[56:71]
    v_mfma_f32_32x32x16_bf16 v[72:87], v[108:111], v[100:103], v[72:87]
    ds_read_b128 v[96:99], v45 offset:0
    ds_read_b128 v[100:103], v49 offset:0
    ds_read_b64_tr_b16 v[108:109], v50 offset:38912
    ds_read_b64_tr_b16 v[110:111], v50 offset:39424
    s_waitcnt lgkmcnt(4)
    v_mfma_f32_32x32x16_bf16 v[56:71], v[104:107], v[88:91], v[56:71]
    v_mfma_f32_32x32x16_bf16 v[72:87], v[104:107], v[92:95], v[72:87]
    s_waitcnt lgkmcnt(0)
    v_mfma_f32_32x32x16_bf16 v[56:71], v[108:111], v[96:99], v[56:71]
    v_mfma_f32_32x32x16_bf16 v[72:87], v[108:111], v[100:103], v[72:87]
    s_waitcnt vmcnt(24)
    s_barrier
    s_mov_b32 s37, 1280
    s_mov_b32 s38, 819200
    s_add_u32 m0, s35, 65536
    s_nop 0
    buffer_load_dwordx4 v28, s[4:7], s37 offen lds
    s_add_u32 m0, s35, 66560
    s_nop 0
    buffer_load_dwordx4 v29, s[4:7], s37 offen lds
    s_add_u32 m0, s35, 67584
    s_nop 0
    buffer_load_dwordx4 v30, s[4:7], s37 offen lds
    s_add_u32 m0, s35, 68608
    s_nop 0
    buffer_load_dwordx4 v31, s[4:7], s37 offen lds
    s_add_u32 m0, s36, 131072
    s_nop 0
    buffer_load_dwordx4 v32, s[8:11], s38 offen lds
    s_add_u32 m0, s36, 132096
    s_nop 0
    buffer_load_dwordx4 v33, s[8:11], s38 offen lds
    ds_read_b128 v[88:91], v42 offset:16384
    ds_read_b128 v[92:95], v46 offset:16384
    ds_read_b64_tr_b16 v[104:105], v50 offset:40960
    ds_read_b64_tr_b16 v[106:107], v50 offset:41472
    ds_read_b128 v[96:99], v43 offset:16384
    ds_read_b128 v[100:103], v47 offset:16384
    ds_read_b64_tr_b16 v[108:109], v50 offset:43008
    ds_read_b64_tr_b16 v[110:111], v50 offset:43520
    s_waitcnt lgkmcnt(4)
    v_mfma_f32_32x32x16_bf16 v[56:71], v[104:107], v[88:91], v[56:71]
    v_mfma_f32_32x32x16_bf16 v[72:87], v[104:107], v[92:95], v[72:87]
    ds_read_b128 v[88:91], v44 offset:16384
    ds_read_b128 v[92:95], v48 offset:16384
    ds_read_b64_tr_b16 v[104:105], v50 offset:45056
    ds_read_b64_tr_b16 v[106:107], v50 offset:45568
    s_waitcnt lgkmcnt(4)
    v_mfma_f32_32x32x16_bf16 v[56:71], v[108:111], v[96:99], v[56:71]
    v_mfma_f32_32x32x16_bf16 v[72:87], v[108:111], v[100:103], v[72:87]
    ds_read_b128 v[96:99], v45 offset:16384
    ds_read_b128 v[100:103], v49 offset:16384
    ds_read_b64_tr_b16 v[108:109], v50 offset:47104
    ds_read_b64_tr_b16 v[110:111], v50 offset:47616
    s_waitcnt lgkmcnt(4)
    v_mfma_f32_32x32x16_bf16 v[56:71], v[104:107], v[88:91], v[56:71]
    v_mfma_f32_32x32x16_bf16 v[72:87], v[104:107], v[92:95], v[72:87]
    s_waitcnt lgkmcnt(0)
    v_mfma_f32_32x32x16_bf16 v[56:71], v[108:111], v[96:99], v[56:71]
    v_mfma_f32_32x32x16_bf16 v[72:87], v[108:111], v[100:103], v[72:87]
    s_waitcnt vmcnt(24)
    s_barrier
    s_mov_b32 s37, 1408
    s_mov_b32 s38, 901120
    s_add_u32 m0, s35, 81920
    s_nop 0
    buffer_load_dwordx4 v28, s[4:7], s37 offen lds
    s_add_u32 m0, s35, 82944
    s_nop 0
    buffer_load_dwordx4 v29, s[4:7], s37 offen lds
    s_add_u32 m0, s35, 83968
    s_nop 0
    buffer_load_dwordx4 v30, s[4:7], s37 offen lds
    s_add_u32 m0, s35, 84992
    s_nop 0
    buffer_load_dwordx4 v31, s[4:7], s37 offen lds
    s_add_u32 m0, s36, 139264
    s_nop 0
    buffer_load_dwordx4 v32, s[8:11], s38 offen lds
    s_add_u32 m0, s36, 140288
    s_nop 0
    buffer_load_dwordx4 v33, s[8:11], s38 offen lds
    ds_read_b128 v[88:91], v34 offset:0
    ds_read_b128 v[92:95], v38 offset:0
    ds_read_b64_tr_b16 v[104:105], v50 offset:0
    ds_read_b64_tr_b16 v[106:107], v50 offset:512
    ds_read_b128 v[96:99], v35 offset:0
    ds_read_b128 v[100:103], v39 offset:0
    ds_read_b64_tr_b16 v[108:109], v50 offset:2048
    ds_read_b64_tr_b16 v[110:111], v50 offset:2560
    s_waitcnt lgkmcnt(4)
    v_mfma_f32_32x32x16_bf16 v[56:71], v[104:107], v[88:91], v[56:71]
    v_mfma_f32_32x32x16_bf16 v[72:87], v[104:107], v[92:95], v[72:87]
    ds_read_b128 v[88:91], v36 offset:0
    ds_read_b128 v[92:95], v40 offset:0
    ds_read_b64_tr_b16 v[104:105], v50 offset:4096
    ds_read_b64_tr_b16 v[106:107], v50 offset:4608
    s_waitcnt lgkmcnt(4)
    v_mfma_f32_32x32x16_bf16 v[56:71], v[108:111], v[96:99], v[56:71]
    v_mfma_f32_32x32x16_bf16 v[72:87], v[108:111], v[100:103], v[72:87]
    ds_read_b128 v[96:99], v37 offset:0
    ds_read_b128 v[100:103], v41 offset:0
    ds_read_b64_tr_b16 v[108:109], v50 offset:6144
    ds_read_b64_tr_b16 v[110:111], v50 offset:6656
    s_waitcnt lgkmcnt(4)
    v_mfma_f32_32x32x16_bf16 v[56:71], v[104:107], v[88:91], v[56:71]
    v_mfma_f32_32x32x16_bf16 v[72:87], v[104:107], v[92:95], v[72:87]
    s_waitcnt lgkmcnt(0)
    v_mfma_f32_32x32x16_bf16 v[56:71], v[108:111], v[96:99], v[56:71]
    v_mfma_f32_32x32x16_bf16 v[72:87], v[108:111], v[100:103], v[72:87]
    s_waitcnt vmcnt(24)
    s_barrier
    s_mov_b32 s37, 1536
    s_mov_b32 s38, 983040
    s_add_u32 m0, s35, 0
    s_nop 0
    buffer_load_dwordx4 v28, s[4:7], s37 offen lds
    s_add_u32 m0, s35, 1024
    s_nop 0
    buffer_load_dwordx4 v29, s[4:7], s37 offen lds
    s_add_u32 m0, s35, 2048
    s_nop 0
    buffer_load_dwordx4 v30, s[4:7], s37 offen lds
    s_add_u32 m0, s35, 3072
    s_nop 0
    buffer_load_dwordx4 v31, s[4:7], s37 offen lds
    s_add_u32 m0, s36, 98304
    s_nop 0
    buffer_load_dwordx4 v32, s[8:11], s38 offen lds
    s_add_u32 m0, s36, 99328
    s_nop 0
    buffer_load_dwordx4 v33, s[8:11], s38 offen lds
    ds_read_b128 v[88:91], v34 offset:16384
    ds_read_b128 v[92:95], v38 offset:16384
    ds_read_b64_tr_b16 v[104:105], v50 offset:8192
    ds_read_b64_tr_b16 v[106:107], v50 offset:8704
    ds_read_b128 v[96:99], v35 offset:16384
    ds_read_b128 v[100:103], v39 offset:16384
    ds_read_b64_tr_b16 v[108:109], v50 offset:10240
    ds_read_b64_tr_b16 v[110:111], v50 offset:10752
    s_waitcnt lgkmcnt(4)
    v_mfma_f32_32x32x16_bf16 v[56:71], v[104:107], v[88:91], v[56:71]
    v_mfma_f32_32x32x16_bf16 v[72:87], v[104:107], v[92:95], v[72:87]
    ds_read_b128 v[88:91], v36 offset:16384
    ds_read_b128 v[92:95], v40 offset:16384
    ds_read_b64_tr_b16 v[104:105], v50 offset:12288
    ds_read_b64_tr_b16 v[106:107], v50 offset:12800
    s_waitcnt lgkmcnt(4)
    v_mfma_f32_32x32x16_bf16 v[56:71], v[108:111], v[96:99], v[56:71]
    v_mfma_f32_32x32x16_bf16 v[72:87], v[108:111], v[100:103], v[72:87]
    ds_read_b128 v[96:99], v37 offset:16384
    ds_read_b128 v[100:103], v41 offset:16384
    ds_read_b64_tr_b16 v[108:109], v50 offset:14336
    ds_read_b64_tr_b16 v[110:111], v50 offset:14848
    s_waitcnt lgkmcnt(4)
    v_mfma_f32_32x32x16_bf16 v[56:71], v[104:107], v[88:91], v[56:71]
    v_mfma_f32_32x32x16_bf16 v[72:87], v[104:107], v[92:95], v[72:87]
    s_waitcnt lgkmcnt(0)
    v_mfma_f32_32x32x16_bf16 v[56:71], v[108:111], v[96:99], v[56:71]
    v_mfma_f32_32x32x16_bf16 v[72:87], v[108:111], v[100:103], v[72:87]
    s_waitcnt vmcnt(24)
    s_barrier
    s_mov_b32 s37, 1664
    s_mov_b32 s38, 1064960
    s_add_u32 m0, s35, 16384
    s_nop 0
    buffer_load_dwordx4 v28, s[4:7], s37 offen lds
    s_add_u32 m0, s35, 17408
    s_nop 0
    buffer_load_dwordx4 v29, s[4:7], s37 offen lds
    s_add_u32 m0, s35, 18432
    s_nop 0
    buffer_load_dwordx4 v30, s[4:7], s37 offen lds
    s_add_u32 m0, s35, 19456
    s_nop 0
    buffer_load_dwordx4 v31, s[4:7], s37 offen lds
    s_add_u32 m0, s36, 106496
    s_nop 0
    buffer_load_dwordx4 v32, s[8:11], s38 offen lds
    s_add_u32 m0, s36, 107520
    s_nop 0
    buffer_load_dwordx4 v33, s[8:11], s38 offen lds
    ds_read_b128 v[88:91], v34 offset:32768
    ds_read_b128 v[92:95], v38 offset:32768
    ds_read_b64_tr_b16 v[104:105], v50 offset:16384
    ds_read_b64_tr_b16 v[106:107], v50 offset:16896
    ds_read_b128 v[96:99], v35 offset:32768
    ds_read_b128 v[100:103], v39 offset:32768
    ds_read_b64_tr_b16 v[108:109], v50 offset:18432
    ds_read_b64_tr_b16 v[110:111], v50 offset:18944
    s_waitcnt lgkmcnt(4)
    v_mfma_f32_32x32x16_bf16 v[56:71], v[104:107], v[88:91], v[56:71]
    v_mfma_f32_32x32x16_bf16 v[72:87], v[104:107], v[92:95], v[72:87]
    ds_read_b128 v[88:91], v36 offset:32768
    ds_read_b128 v[92:95], v40 offset:32768
    ds_read_b64_tr_b16 v[104:105], v50 offset:20480
    ds_read_b64_tr_b16 v[106:107], v50 offset:20992
    s_waitcnt lgkmcnt(4)
    v_mfma_f32_32x32x16_bf16 v[56:71], v[108:111], v[96:99], v[56:71]
    v_mfma_f32_32x32x16_bf16 v[72:87], v[108:111], v[100:103], v[72:87]
    ds_read_b128 v[96:99], v37 offset:32768
    ds_read_b128 v[100:103], v41 offset:32768
    ds_read_b64_tr_b16 v[108:109], v50 offset:22528
    ds_read_b64_tr_b16 v[110:111], v50 offset:23040
    s_waitcnt lgkmcnt(4)
    v_mfma_f32_32x32x16_bf16 v[56:71], v[104:107], v[88:91], v[56:71]
    v_mfma_f32_32x32x16_bf16 v[72:87], v[104:107], v[92:95], v[72:87]
    s_waitcnt lgkmcnt(0)
    v_mfma_f32_32x32x16_bf16 v[56:71], v[108:111], v[96:99], v[56:71]
    v_mfma_f32_32x32x16_bf16 v[72:87], v[108:111], v[100:103], v[72:87]
    s_waitcnt vmcnt(24)
    s_barrier
    s_mov_b32 s37, 1792
    s_mov_b32 s38, 1146880
    s_add_u32 m0, s35, 32768
    s_nop 0
    buffer_load_dwordx4 v28, s[4:7], s37 offen lds
    s_add_u32 m0, s35, 33792
    s_nop 0
    buffer_load_dwordx4 v29, s[4:7], s37 offen lds
    s_add_u32 m0, s35, 34816
    s_nop 0
    buffer_load_dwordx4 v30, s[4:7], s37 offen lds
    s_add_u32 m0, s35, 35840
    s_nop 0
    buffer_load_dwordx4 v31, s[4:7], s37 offen lds
    s_add_u32 m0, s36, 114688
    s_nop 0
    buffer_load_dwordx4 v32, s[8:11], s38 offen lds
    s_add_u32 m0, s36, 115712
    s_nop 0
    buffer_load_dwordx4 v33, s[8:11], s38 offen lds
    ds_read_b128 v[88:91], v34 offset:49152
    ds_read_b128 v[92:95], v38 offset:49152
    ds_read_b64_tr_b16 v[104:105], v50 offset:24576
    ds_read_b64_tr_b16 v[106:107], v50 offset:25088
    ds_read_b128 v[96:99], v35 offset:49152
    ds_read_b128 v[100:103], v39 offset:49152
    ds_read_b64_tr_b16 v[108:109], v50 offset:26624
    ds_read_b64_tr_b16 v[110:111], v50 offset:27136
    s_waitcnt lgkmcnt(4)
    v_mfma_f32_32x32x16_bf16 v[56:71], v[104:107], v[88:91], v[56:71]
    v_mfma_f32_32x32x16_bf16 v[72:87], v[104:107], v[92:95], v[72:87]
    ds_read_b128 v[88:91], v36 offset:49152
    ds_read_b128 v[92:95], v40 offset:49152
    ds_read_b64_tr_b16 v[104:105], v50 offset:28672
    ds_read_b64_tr_b16 v[106:107], v50 offset:29184
    s_waitcnt lgkmcnt(4)
    v_mfma_f32_32x32x16_bf16 v[56:71], v[108:111], v[96:99], v[56:71]
    v_mfma_f32_32x32x16_bf16 v[72:87], v[108:111], v[100:103], v[72:87]
    ds_read_b128 v[96:99], v37 offset:49152
    ds_read_b128 v[100:103], v41 offset:49152
    ds_read_b64_tr_b16 v[108:109], v50 offset:30720
    ds_read_b64_tr_b16 v[110:111], v50 offset:31232
    s_waitcnt lgkmcnt(4)
    v_mfma_f32_32x32x16_bf16 v[56:71], v[104:107], v[88:91], v[56:71]
    v_mfma_f32_32x32x16_bf16 v[72:87], v[104:107], v[92:95], v[72:87]
    s_waitcnt lgkmcnt(0)
    v_mfma_f32_32x32x16_bf16 v[56:71], v[108:111], v[96:99], v[56:71]
    v_mfma_f32_32x32x16_bf16 v[72:87], v[108:111], v[100:103], v[72:87]
    s_waitcnt vmcnt(24)
    s_barrier
    s_mov_b32 s37, 1920
    s_mov_b32 s38, 1228800
    s_add_u32 m0, s35, 49152
    s_nop 0
    buffer_load_dwordx4 v28, s[4:7], s37 offen lds
    s_add_u32 m0, s35, 50176
    s_nop 0
    buffer_load_dwordx4 v29, s[4:7], s37 offen lds
    s_add_u32 m0, s35, 51200
    s_nop 0
    buffer_load_dwordx4 v30, s[4:7], s37 offen lds
    s_add_u32 m0, s35, 52224
    s_nop 0
    buffer_load_dwordx4 v31, s[4:7], s37 offen lds
    s_add_u32 m0, s36, 122880
    s_nop 0
    buffer_load_dwordx4 v32, s[8:11], s38 offen lds
    s_add_u32 m0, s36, 123904
    s_nop 0
    buffer_load_dwordx4 v33, s[8:11], s38 offen lds
    ds_read_b128 v[88:91], v42 offset:0
    ds_read_b128 v[92:95], v46 offset:0
    ds_read_b64_tr_b16 v[104:105], v50 offset:32768
    ds_read_b64_tr_b16 v[106:107], v50 offset:33280
    ds_read_b128 v[96:99], v43 offset:0
    ds_read_b128 v[100:103], v47 offset:0
    ds_read_b64_tr_b16 v[108:109], v50 offset:34816
    ds_read_b64_tr_b16 v[110:111], v50 offset:35328
    s_waitcnt lgkmcnt(4)
    v_mfma_f32_32x32x16_bf16 v[56:71], v[104:107], v[88:91], v[56:71]
    v_mfma_f32_32x32x16_bf16 v[72:87], v[104:107], v[92:95], v[72:87]
    ds_read_b128 v[88:91], v44 offset:0
    ds_read_b128 v[92:95], v48 offset:0
    ds_read_b64_tr_b16 v[104:105], v50 offset:36864
    ds_read_b64_tr_b16 v[106:107], v50 offset:37376
    s_waitcnt lgkmcnt(4)
    v_mfma_f32_32x32x16_bf16 v[56:71], v[108:111], v[96:99], v[56:71]
    v_mfma_f32_32x32x16_bf16 v[72:87], v[108:111], v[100:103], v[72:87]
    ds_read_b128 v[96:99], v45 offset:0
    ds_read_b128 v[100:103], v49 offset:0
    ds_read_b64_tr_b16 v[108:109], v50 offset:38912
    ds_read_b64_tr_b16 v[110:111], v50 offset:39424
    s_waitcnt lgkmcnt(4)
    v_mfma_f32_32x32x16_bf16 v[56:71], v[104:107], v[88:91], v[56:71]
    v_mfma_f32_32x32x16_bf16 v[72:87], v[104:107], v[92:95], v[72:87]
    s_waitcnt lgkmcnt(0)
    v_mfma_f32_32x32x16_bf16 v[56:71], v[108:111], v[96:99], v[56:71]
    v_mfma_f32_32x32x16_bf16 v[72:87], v[108:111], v[100:103], v[72:87]
    s_waitcnt vmcnt(24)
    s_barrier
    s_mov_b32 s37, 2048
    s_mov_b32 s38, 1310720
    s_add_u32 m0, s35, 65536
    s_nop 0
    buffer_load_dwordx4 v28, s[4:7], s37 offen lds
    s_add_u32 m0, s35, 66560
    s_nop 0
    buffer_load_dwordx4 v29, s[4:7], s37 offen lds
    s_add_u32 m0, s35, 67584
    s_nop 0
    buffer_load_dwordx4 v30, s[4:7], s37 offen lds
    s_add_u32 m0, s35, 68608
    s_nop 0
    buffer_load_dwordx4 v31, s[4:7], s37 offen lds
    s_add_u32 m0, s36, 131072
    s_nop 0
    buffer_load_dwordx4 v32, s[8:11], s38 offen lds
    s_add_u32 m0, s36, 132096
    s_nop 0
    buffer_load_dwordx4 v33, s[8:11], s38 offen lds
    ds_read_b128 v[88:91], v42 offset:16384
    ds_read_b128 v[92:95], v46 offset:16384
    ds_read_b64_tr_b16 v[104:105], v50 offset:40960
    ds_read_b64_tr_b16 v[106:107], v50 offset:41472
    ds_read_b128 v[96:99], v43 offset:16384
    ds_read_b128 v[100:103], v47 offset:16384
    ds_read_b64_tr_b16 v[108:109], v50 offset:43008
    ds_read_b64_tr_b16 v[110:111], v50 offset:43520
    s_waitcnt lgkmcnt(4)
    v_mfma_f32_32x32x16_bf16 v[56:71], v[104:107], v[88:91], v[56:71]
    v_mfma_f32_32x32x16_bf16 v[72:87], v[104:107], v[92:95], v[72:87]
    ds_read_b128 v[88:91], v44 offset:16384
    ds_read_b128 v[92:95], v48 offset:16384
    ds_read_b64_tr_b16 v[104:105], v50 offset:45056
    ds_read_b64_tr_b16 v[106:107], v50 offset:45568
    s_waitcnt lgkmcnt(4)
    v_mfma_f32_32x32x16_bf16 v[56:71], v[108:111], v[96:99], v[56:71]
    v_mfma_f32_32x32x16_bf16 v[72:87], v[108:111], v[100:103], v[72:87]
    ds_read_b128 v[96:99], v45 offset:16384
    ds_read_b128 v[100:103], v49 offset:16384
    ds_read_b64_tr_b16 v[108:109], v50 offset:47104
    ds_read_b64_tr_b16 v[110:111], v50 offset:47616
    s_waitcnt lgkmcnt(4)
    v_mfma_f32_32x32x16_bf16 v[56:71], v[104:107], v[88:91], v[56:71]
    v_mfma_f32_32x32x16_bf16 v[72:87], v[104:107], v[92:95], v[72:87]
    s_waitcnt lgkmcnt(0)
    v_mfma_f32_32x32x16_bf16 v[56:71], v[108:111], v[96:99], v[56:71]
    v_mfma_f32_32x32x16_bf16 v[72:87], v[108:111], v[100:103], v[72:87]
    s_waitcnt vmcnt(24)
    s_barrier
    s_mov_b32 s37, 2176
    s_mov_b32 s38, 1392640
    s_add_u32 m0, s35, 81920
    s_nop 0
    buffer_load_dwordx4 v28, s[4:7], s37 offen lds
    s_add_u32 m0, s35, 82944
    s_nop 0
    buffer_load_dwordx4 v29, s[4:7], s37 offen lds
    s_add_u32 m0, s35, 83968
    s_nop 0
    buffer_load_dwordx4 v30, s[4:7], s37 offen lds
    s_add_u32 m0, s35, 84992
    s_nop 0
    buffer_load_dwordx4 v31, s[4:7], s37 offen lds
    s_add_u32 m0, s36, 139264
    s_nop 0
    buffer_load_dwordx4 v32, s[8:11], s38 offen lds
    s_add_u32 m0, s36, 140288
    s_nop 0
    buffer_load_dwordx4 v33, s[8:11], s38 offen lds
    ds_read_b128 v[88:91], v34 offset:0
    ds_read_b128 v[92:95], v38 offset:0
    ds_read_b64_tr_b16 v[104:105], v50 offset:0
    ds_read_b64_tr_b16 v[106:107], v50 offset:512
    ds_read_b128 v[96:99], v35 offset:0
    ds_read_b128 v[100:103], v39 offset:0
    ds_read_b64_tr_b16 v[108:109], v50 offset:2048
    ds_read_b64_tr_b16 v[110:111], v50 offset:2560
    s_waitcnt lgkmcnt(4)
    v_mfma_f32_32x32x16_bf16 v[56:71], v[104:107], v[88:91], v[56:71]
    v_mfma_f32_32x32x16_bf16 v[72:87], v[104:107], v[92:95], v[72:87]
    ds_read_b128 v[88:91], v36 offset:0
    ds_read_b128 v[92:95], v40 offset:0
    ds_read_b64_tr_b16 v[104:105], v50 offset:4096
    ds_read_b64_tr_b16 v[106:107], v50 offset:4608
    s_waitcnt lgkmcnt(4)
    v_mfma_f32_32x32x16_bf16 v[56:71], v[108:111], v[96:99], v[56:71]
    v_mfma_f32_32x32x16_bf16 v[72:87], v[108:111], v[100:103], v[72:87]
    ds_read_b128 v[96:99], v37 offset:0
    ds_read_b128 v[100:103], v41 offset:0
    ds_read_b64_tr_b16 v[108:109], v50 offset:6144
    ds_read_b64_tr_b16 v[110:111], v50 offset:6656
    s_waitcnt lgkmcnt(4)
    v_mfma_f32_32x32x16_bf16 v[56:71], v[104:107], v[88:91], v[56:71]
    v_mfma_f32_32x32x16_bf16 v[72:87], v[104:107], v[92:95], v[72:87]
    s_waitcnt lgkmcnt(0)
    v_mfma_f32_32x32x16_bf16 v[56:71], v[108:111], v[96:99], v[56:71]
    v_mfma_f32_32x32x16_bf16 v[72:87], v[108:111], v[100:103], v[72:87]
    s_waitcnt vmcnt(24)
    s_barrier
    s_mov_b32 s37, 2304
    s_mov_b32 s38, 1474560
    s_add_u32 m0, s35, 0
    s_nop 0
    buffer_load_dwordx4 v28, s[4:7], s37 offen lds
    s_add_u32 m0, s35, 1024
    s_nop 0
    buffer_load_dwordx4 v29, s[4:7], s37 offen lds
    s_add_u32 m0, s35, 2048
    s_nop 0
    buffer_load_dwordx4 v30, s[4:7], s37 offen lds
    s_add_u32 m0, s35, 3072
    s_nop 0
    buffer_load_dwordx4 v31, s[4:7], s37 offen lds
    s_add_u32 m0, s36, 98304
    s_nop 0
    buffer_load_dwordx4 v32, s[8:11], s38 offen lds
    s_add_u32 m0, s36, 99328
    s_nop 0
    buffer_load_dwordx4 v33, s[8:11], s38 offen lds
    ds_read_b128 v[88:91], v34 offset:16384
    ds_read_b128 v[92:95], v38 offset:16384
    ds_read_b64_tr_b16 v[104:105], v50 offset:8192
    ds_read_b64_tr_b16 v[106:107], v50 offset:8704
    ds_read_b128 v[96:99], v35 offset:16384
    ds_read_b128 v[100:103], v39 offset:16384
    ds_read_b64_tr_b16 v[108:109], v50 offset:10240
    ds_read_b64_tr_b16 v[110:111], v50 offset:10752
    s_waitcnt lgkmcnt(4)
    v_mfma_f32_32x32x16_bf16 v[56:71], v[104:107], v[88:91], v[56:71]
    v_mfma_f32_32x32x16_bf16 v[72:87], v[104:107], v[92:95], v[72:87]
    ds_read_b128 v[88:91], v36 offset:16384
    ds_read_b128 v[92:95], v40 offset:16384
    ds_read_b64_tr_b16 v[104:105], v50 offset:12288
    ds_read_b64_tr_b16 v[106:107], v50 offset:12800
    s_waitcnt lgkmcnt(4)
    v_mfma_f32_32x32x16_bf16 v[56:71], v[108:111], v[96:99], v[56:71]
    v_mfma_f32_32x32x16_bf16 v[72:87], v[108:111], v[100:103], v[72:87]
    ds_read_b128 v[96:99], v37 offset:16384
    ds_read_b128 v[100:103], v41 offset:16384
    ds_read_b64_tr_b16 v[108:109], v50 offset:14336
    ds_read_b64_tr_b16 v[110:111], v50 offset:14848
    s_waitcnt lgkmcnt(4)
    v_mfma_f32_32x32x16_bf16 v[56:71], v[104:107], v[88:91], v[56:71]
    v_mfma_f32_32x32x16_bf16 v[72:87], v[104:107], v[92:95], v[72:87]
    s_waitcnt lgkmcnt(0)
    v_mfma_f32_32x32x16_bf16 v[56:71], v[108:111], v[96:99], v[56:71]
    v_mfma_f32_32x32x16_bf16 v[72:87], v[108:111], v[100:103], v[72:87]
    s_waitcnt vmcnt(24)
    s_barrier
    s_mov_b32 s37, 2432
    s_mov_b32 s38, 1556480
    s_add_u32 m0, s35, 16384
    s_nop 0
    buffer_load_dwordx4 v28, s[4:7], s37 offen lds
    s_add_u32 m0, s35, 17408
    s_nop 0
    buffer_load_dwordx4 v29, s[4:7], s37 offen lds
    s_add_u32 m0, s35, 18432
    s_nop 0
    buffer_load_dwordx4 v30, s[4:7], s37 offen lds
    s_add_u32 m0, s35, 19456
    s_nop 0
    buffer_load_dwordx4 v31, s[4:7], s37 offen lds
    s_add_u32 m0, s36, 106496
    s_nop 0
    buffer_load_dwordx4 v32, s[8:11], s38 offen lds
    s_add_u32 m0, s36, 107520
    s_nop 0
    buffer_load_dwordx4 v33, s[8:11], s38 offen lds
    ds_read_b128 v[88:91], v34 offset:32768
    ds_read_b128 v[92:95], v38 offset:32768
    ds_read_b64_tr_b16 v[104:105], v50 offset:16384
    ds_read_b64_tr_b16 v[106:107], v50 offset:16896
    ds_read_b128 v[96:99], v35 offset:32768
    ds_read_b128 v[100:103], v39 offset:32768
    ds_read_b64_tr_b16 v[108:109], v50 offset:18432
    ds_read_b64_tr_b16 v[110:111], v50 offset:18944
    s_waitcnt lgkmcnt(4)
    v_mfma_f32_32x32x16_bf16 v[56:71], v[104:107], v[88:91], v[56:71]
    v_mfma_f32_32x32x16_bf16 v[72:87], v[104:107], v[92:95], v[72:87]
    ds_read_b128 v[88:91], v36 offset:32768
    ds_read_b128 v[92:95], v40 offset:32768
    ds_read_b64_tr_b16 v[104:105], v50 offset:20480
    ds_read_b64_tr_b16 v[106:107], v50 offset:20992
    s_waitcnt lgkmcnt(4)
    v_mfma_f32_32x32x16_bf16 v[56:71], v[108:111], v[96:99], v[56:71]
    v_mfma_f32_32x32x16_bf16 v[72:87], v[108:111], v[100:103], v[72:87]
    ds_read_b128 v[96:99], v37 offset:32768
    ds_read_b128 v[100:103], v41 offset:32768
    ds_read_b64_tr_b16 v[108:109], v50 offset:22528
    ds_read_b64_tr_b16 v[110:111], v50 offset:23040
    s_waitcnt lgkmcnt(4)
    v_mfma_f32_32x32x16_bf16 v[56:71], v[104:107], v[88:91], v[56:71]
    v_mfma_f32_32x32x16_bf16 v[72:87], v[104:107], v[92:95], v[72:87]
    s_waitcnt lgkmcnt(0)
    v_mfma_f32_32x32x16_bf16 v[56:71], v[108:111], v[96:99], v[56:71]
    v_mfma_f32_32x32x16_bf16 v[72:87], v[108:111], v[100:103], v[72:87]
    s_waitcnt vmcnt(24)
    s_barrier
    s_mov_b32 s37, 2560
    s_mov_b32 s38, 1638400
    s_add_u32 m0, s35, 32768
    s_nop 0
    buffer_load_dwordx4 v28, s[4:7], s37 offen lds
    s_add_u32 m0, s35, 33792
    s_nop 0
    buffer_load_dwordx4 v29, s[4:7], s37 offen lds
    s_add_u32 m0, s35, 34816
    s_nop 0
    buffer_load_dwordx4 v30, s[4:7], s37 offen lds
    s_add_u32 m0, s35, 35840
    s_nop 0
    buffer_load_dwordx4 v31, s[4:7], s37 offen lds
    s_add_u32 m0, s36, 114688
    s_nop 0
    buffer_load_dwordx4 v32, s[8:11], s38 offen lds
    s_add_u32 m0, s36, 115712
    s_nop 0
    buffer_load_dwordx4 v33, s[8:11], s38 offen lds
    ds_read_b128 v[88:91], v34 offset:49152
    ds_read_b128 v[92:95], v38 offset:49152
    ds_read_b64_tr_b16 v[104:105], v50 offset:24576
    ds_read_b64_tr_b16 v[106:107], v50 offset:25088
    ds_read_b128 v[96:99], v35 offset:49152
    ds_read_b128 v[100:103], v39 offset:49152
    ds_read_b64_tr_b16 v[108:109], v50 offset:26624
    ds_read_b64_tr_b16 v[110:111], v50 offset:27136
    s_waitcnt lgkmcnt(4)
    v_mfma_f32_32x32x16_bf16 v[56:71], v[104:107], v[88:91], v[56:71]
    v_mfma_f32_32x32x16_bf16 v[72:87], v[104:107], v[92:95], v[72:87]
    ds_read_b128 v[88:91], v36 offset:49152
    ds_read_b128 v[92:95], v40 offset:49152
    ds_read_b64_tr_b16 v[104:105], v50 offset:28672
    ds_read_b64_tr_b16 v[106:107], v50 offset:29184
    s_waitcnt lgkmcnt(4)
    v_mfma_f32_32x32x16_bf16 v[56:71], v[108:111], v[96:99], v[56:71]
    v_mfma_f32_32x32x16_bf16 v[72:87], v[108:111], v[100:103], v[72:87]
    ds_read_b128 v[96:99], v37 offset:49152
    ds_read_b128 v[100:103], v41 offset:49152
    ds_read_b64_tr_b16 v[108:109], v50 offset:30720
    ds_read_b64_tr_b16 v[110:111], v50 offset:31232
    s_waitcnt lgkmcnt(4)
    v_mfma_f32_32x32x16_bf16 v[56:71], v[104:107], v[88:91], v[56:71]
    v_mfma_f32_32x32x16_bf16 v[72:87], v[104:107], v[92:95], v[72:87]
    s_waitcnt lgkmcnt(0)
    v_mfma_f32_32x32x16_bf16 v[56:71], v[108:111], v[96:99], v[56:71]
    v_mfma_f32_32x32x16_bf16 v[72:87], v[108:111], v[100:103], v[72:87]
    s_waitcnt vmcnt(24)
    s_barrier
    s_mov_b32 s37, 2688
    s_mov_b32 s38, 1720320
    s_add_u32 m0, s35, 49152
    s_nop 0
    buffer_load_dwordx4 v28, s[4:7], s37 offen lds
    s_add_u32 m0, s35, 50176
    s_nop 0
    buffer_load_dwordx4 v29, s[4:7], s37 offen lds
    s_add_u32 m0, s35, 51200
    s_nop 0
    buffer_load_dwordx4 v30, s[4:7], s37 offen lds
    s_add_u32 m0, s35, 52224
    s_nop 0
    buffer_load_dwordx4 v31, s[4:7], s37 offen lds
    s_add_u32 m0, s36, 122880
    s_nop 0
    buffer_load_dwordx4 v32, s[8:11], s38 offen lds
    s_add_u32 m0, s36, 123904
    s_nop 0
    buffer_load_dwordx4 v33, s[8:11], s38 offen lds
    ds_read_b128 v[88:91], v42 offset:0
    ds_read_b128 v[92:95], v46 offset:0
    ds_read_b64_tr_b16 v[104:105], v50 offset:32768
    ds_read_b64_tr_b16 v[106:107], v50 offset:33280
    ds_read_b128 v[96:99], v43 offset:0
    ds_read_b128 v[100:103], v47 offset:0
    ds_read_b64_tr_b16 v[108:109], v50 offset:34816
    ds_read_b64_tr_b16 v[110:111], v50 offset:35328
    s_waitcnt lgkmcnt(4)
    v_mfma_f32_32x32x16_bf16 v[56:71], v[104:107], v[88:91], v[56:71]
    v_mfma_f32_32x32x16_bf16 v[72:87], v[104:107], v[92:95], v[72:87]
    ds_read_b128 v[88:91], v44 offset:0
    ds_read_b128 v[92:95], v48 offset:0
    ds_read_b64_tr_b16 v[104:105], v50 offset:36864
    ds_read_b64_tr_b16 v[106:107], v50 offset:37376
    s_waitcnt lgkmcnt(4)
    v_mfma_f32_32x32x16_bf16 v[56:71], v[108:111], v[96:99], v[56:71]
    v_mfma_f32_32x32x16_bf16 v[72:87], v[108:111], v[100:103], v[72:87]
    ds_read_b128 v[96:99], v45 offset:0
    ds_read_b128 v[100:103], v49 offset:0
    ds_read_b64_tr_b16 v[108:109], v50 offset:38912
    ds_read_b64_tr_b16 v[110:111], v50 offset:39424
    s_waitcnt lgkmcnt(4)
    v_mfma_f32_32x32x16_bf16 v[56:71], v[104:107], v[88:91], v[56:71]
    v_mfma_f32_32x32x16_bf16 v[72:87], v[104:107], v[92:95], v[72:87]
    s_waitcnt lgkmcnt(0)
    v_mfma_f32_32x32x16_bf16 v[56:71], v[108:111], v[96:99], v[56:71]
    v_mfma_f32_32x32x16_bf16 v[72:87], v[108:111], v[100:103], v[72:87]
    s_waitcnt vmcnt(24)
    s_barrier
    s_mov_b32 s37, 2816
    s_mov_b32 s38, 1802240
    s_add_u32 m0, s35, 65536
    s_nop 0
    buffer_load_dwordx4 v28, s[4:7], s37 offen lds
    s_add_u32 m0, s35, 66560
    s_nop 0
    buffer_load_dwordx4 v29, s[4:7], s37 offen lds
    s_add_u32 m0, s35, 67584
    s_nop 0
    buffer_load_dwordx4 v30, s[4:7], s37 offen lds
    s_add_u32 m0, s35, 68608
    s_nop 0
    buffer_load_dwordx4 v31, s[4:7], s37 offen lds
    s_add_u32 m0, s36, 131072
    s_nop 0
    buffer_load_dwordx4 v32, s[8:11], s38 offen lds
    s_add_u32 m0, s36, 132096
    s_nop 0
    buffer_load_dwordx4 v33, s[8:11], s38 offen lds
    ds_read_b128 v[88:91], v42 offset:16384
    ds_read_b128 v[92:95], v46 offset:16384
    ds_read_b64_tr_b16 v[104:105], v50 offset:40960
    ds_read_b64_tr_b16 v[106:107], v50 offset:41472
    ds_read_b128 v[96:99], v43 offset:16384
    ds_read_b128 v[100:103], v47 offset:16384
    ds_read_b64_tr_b16 v[108:109], v50 offset:43008
    ds_read_b64_tr_b16 v[110:111], v50 offset:43520
    s_waitcnt lgkmcnt(4)
    v_mfma_f32_32x32x16_bf16 v[56:71], v[104:107], v[88:91], v[56:71]
    v_mfma_f32_32x32x16_bf16 v[72:87], v[104:107], v[92:95], v[72:87]
    ds_read_b128 v[88:91], v44 offset:16384
    ds_read_b128 v[92:95], v48 offset:16384
    ds_read_b64_tr_b16 v[104:105], v50 offset:45056
    ds_read_b64_tr_b16 v[106:107], v50 offset:45568
    s_waitcnt lgkmcnt(4)
    v_mfma_f32_32x32x16_bf16 v[56:71], v[108:111], v[96:99], v[56:71]
    v_mfma_f32_32x32x16_bf16 v[72:87], v[108:111], v[100:103], v[72:87]
    ds_read_b128 v[96:99], v45 offset:16384
    ds_read_b128 v[100:103], v49 offset:16384
    ds_read_b64_tr_b16 v[108:109], v50 offset:47104
    ds_read_b64_tr_b16 v[110:111], v50 offset:47616
    s_waitcnt lgkmcnt(4)
    v_mfma_f32_32x32x16_bf16 v[56:71], v[104:107], v[88:91], v[56:71]
    v_mfma_f32_32x32x16_bf16 v[72:87], v[104:107], v[92:95], v[72:87]
    s_waitcnt lgkmcnt(0)
    v_mfma_f32_32x32x16_bf16 v[56:71], v[108:111], v[96:99], v[56:71]
    v_mfma_f32_32x32x16_bf16 v[72:87], v[108:111], v[100:103], v[72:87]
    s_waitcnt vmcnt(24)
    s_barrier
    s_mov_b32 s37, 2944
    s_mov_b32 s38, 1884160
    s_add_u32 m0, s35, 81920
    s_nop 0
    buffer_load_dwordx4 v28, s[4:7], s37 offen lds
    s_add_u32 m0, s35, 82944
    s_nop 0
    buffer_load_dwordx4 v29, s[4:7], s37 offen lds
    s_add_u32 m0, s35, 83968
    s_nop 0
    buffer_load_dwordx4 v30, s[4:7], s37 offen lds
    s_add_u32 m0, s35, 84992
    s_nop 0
    buffer_load_dwordx4 v31, s[4:7], s37 offen lds
    s_add_u32 m0, s36, 139264
    s_nop 0
    buffer_load_dwordx4 v32, s[8:11], s38 offen lds
    s_add_u32 m0, s36, 140288
    s_nop 0
    buffer_load_dwordx4 v33, s[8:11], s38 offen lds
    ds_read_b128 v[88:91], v34 offset:0
    ds_read_b128 v[92:95], v38 offset:0
    ds_read_b64_tr_b16 v[104:105], v50 offset:0
    ds_read_b64_tr_b16 v[106:107], v50 offset:512
    ds_read_b128 v[96:99], v35 offset:0
    ds_read_b128 v[100:103], v39 offset:0
    ds_read_b64_tr_b16 v[108:109], v50 offset:2048
    ds_read_b64_tr_b16 v[110:111], v50 offset:2560
    s_waitcnt lgkmcnt(4)
    v_mfma_f32_32x32x16_bf16 v[56:71], v[104:107], v[88:91], v[56:71]
    v_mfma_f32_32x32x16_bf16 v[72:87], v[104:107], v[92:95], v[72:87]
    ds_read_b128 v[88:91], v36 offset:0
    ds_read_b128 v[92:95], v40 offset:0
    ds_read_b64_tr_b16 v[104:105], v50 offset:4096
    ds_read_b64_tr_b16 v[106:107], v50 offset:4608
    s_waitcnt lgkmcnt(4)
    v_mfma_f32_32x32x16_bf16 v[56:71], v[108:111], v[96:99], v[56:71]
    v_mfma_f32_32x32x16_bf16 v[72:87], v[108:111], v[100:103], v[72:87]
    ds_read_b128 v[96:99], v37 offset:0
    ds_read_b128 v[100:103], v41 offset:0
    ds_read_b64_tr_b16 v[108:109], v50 offset:6144
    ds_read_b64_tr_b16 v[110:111], v50 offset:6656
    s_waitcnt lgkmcnt(4)
    v_mfma_f32_32x32x16_bf16 v[56:71], v[104:107], v[88:91], v[56:71]
    v_mfma_f32_32x32x16_bf16 v[72:87], v[104:107], v[92:95], v[72:87]
    s_waitcnt lgkmcnt(0)
    v_mfma_f32_32x32x16_bf16 v[56:71], v[108:111], v[96:99], v[56:71]
    v_mfma_f32_32x32x16_bf16 v[72:87], v[108:111], v[100:103], v[72:87]
    s_waitcnt vmcnt(24)
    s_barrier
    s_mov_b32 s37, 3072
    s_mov_b32 s38, 1966080
    s_add_u32 m0, s35, 0
    s_nop 0
    buffer_load_dwordx4 v28, s[4:7], s37 offen lds
    s_add_u32 m0, s35, 1024
    s_nop 0
    buffer_load_dwordx4 v29, s[4:7], s37 offen lds
    s_add_u32 m0, s35, 2048
    s_nop 0
    buffer_load_dwordx4 v30, s[4:7], s37 offen lds
    s_add_u32 m0, s35, 3072
    s_nop 0
    buffer_load_dwordx4 v31, s[4:7], s37 offen lds
    s_add_u32 m0, s36, 98304
    s_nop 0
    buffer_load_dwordx4 v32, s[8:11], s38 offen lds
    s_add_u32 m0, s36, 99328
    s_nop 0
    buffer_load_dwordx4 v33, s[8:11], s38 offen lds
    ds_read_b128 v[88:91], v34 offset:16384
    ds_read_b128 v[92:95], v38 offset:16384
    ds_read_b64_tr_b16 v[104:105], v50 offset:8192
    ds_read_b64_tr_b16 v[106:107], v50 offset:8704
    ds_read_b128 v[96:99], v35 offset:16384
    ds_read_b128 v[100:103], v39 offset:16384
    ds_read_b64_tr_b16 v[108:109], v50 offset:10240
    ds_read_b64_tr_b16 v[110:111], v50 offset:10752
    s_waitcnt lgkmcnt(4)
    v_mfma_f32_32x32x16_bf16 v[56:71], v[104:107], v[88:91], v[56:71]
    v_mfma_f32_32x32x16_bf16 v[72:87], v[104:107], v[92:95], v[72:87]
    ds_read_b128 v[88:91], v36 offset:16384
    ds_read_b128 v[92:95], v40 offset:16384
    ds_read_b64_tr_b16 v[104:105], v50 offset:12288
    ds_read_b64_tr_b16 v[106:107], v50 offset:12800
    s_waitcnt lgkmcnt(4)
    v_mfma_f32_32x32x16_bf16 v[56:71], v[108:111], v[96:99], v[56:71]
    v_mfma_f32_32x32x16_bf16 v[72:87], v[108:111], v[100:103], v[72:87]
    ds_read_b128 v[96:99], v37 offset:16384
    ds_read_b128 v[100:103], v41 offset:16384
    ds_read_b64_tr_b16 v[108:109], v50 offset:14336
    ds_read_b64_tr_b16 v[110:111], v50 offset:14848
    s_waitcnt lgkmcnt(4)
    v_mfma_f32_32x32x16_bf16 v[56:71], v[104:107], v[88:91], v[56:71]
    v_mfma_f32_32x32x16_bf16 v[72:87], v[104:107], v[92:95], v[72:87]
    s_waitcnt lgkmcnt(0)
    v_mfma_f32_32x32x16_bf16 v[56:71], v[108:111], v[96:99], v[56:71]
    v_mfma_f32_32x32x16_bf16 v[72:87], v[108:111], v[100:103], v[72:87]
    s_waitcnt vmcnt(24)
    s_barrier
    s_mov_b32 s37, 3200
    s_mov_b32 s38, 2048000
    s_add_u32 m0, s35, 16384
    s_nop 0
    buffer_load_dwordx4 v28, s[4:7], s37 offen lds
    s_add_u32 m0, s35, 17408
    s_nop 0
    buffer_load_dwordx4 v29, s[4:7], s37 offen lds
    s_add_u32 m0, s35, 18432
    s_nop 0
    buffer_load_dwordx4 v30, s[4:7], s37 offen lds
    s_add_u32 m0, s35, 19456
    s_nop 0
    buffer_load_dwordx4 v31, s[4:7], s37 offen lds
    s_add_u32 m0, s36, 106496
    s_nop 0
    buffer_load_dwordx4 v32, s[8:11], s38 offen lds
    s_add_u32 m0, s36, 107520
    s_nop 0
    buffer_load_dwordx4 v33, s[8:11], s38 offen lds
    ds_read_b128 v[88:91], v34 offset:32768
    ds_read_b128 v[92:95], v38 offset:32768
    ds_read_b64_tr_b16 v[104:105], v50 offset:16384
    ds_read_b64_tr_b16 v[106:107], v50 offset:16896
    ds_read_b128 v[96:99], v35 offset:32768
    ds_read_b128 v[100:103], v39 offset:32768
    ds_read_b64_tr_b16 v[108:109], v50 offset:18432
    ds_read_b64_tr_b16 v[110:111], v50 offset:18944
    s_waitcnt lgkmcnt(4)
    v_mfma_f32_32x32x16_bf16 v[56:71], v[104:107], v[88:91], v[56:71]
    v_mfma_f32_32x32x16_bf16 v[72:87], v[104:107], v[92:95], v[72:87]
    ds_read_b128 v[88:91], v36 offset:32768
    ds_read_b128 v[92:95], v40 offset:32768
    ds_read_b64_tr_b16 v[104:105], v50 offset:20480
    ds_read_b64_tr_b16 v[106:107], v50 offset:20992
    s_waitcnt lgkmcnt(4)
    v_mfma_f32_32x32x16_bf16 v[56:71], v[108:111], v[96:99], v[56:71]
    v_mfma_f32_32x32x16_bf16 v[72:87], v[108:111], v[100:103], v[72:87]
    ds_read_b128 v[96:99], v37 offset:32768
    ds_read_b128 v[100:103], v41 offset:32768
    ds_read_b64_tr_b16 v[108:109], v50 offset:22528
    ds_read_b64_tr_b16 v[110:111], v50 offset:23040
    s_waitcnt lgkmcnt(4)
    v_mfma_f32_32x32x16_bf16 v[56:71], v[104:107], v[88:91], v[56:71]
    v_mfma_f32_32x32x16_bf16 v[72:87], v[104:107], v[92:95], v[72:87]
    s_waitcnt lgkmcnt(0)
    v_mfma_f32_32x32x16_bf16 v[56:71], v[108:111], v[96:99], v[56:71]
    v_mfma_f32_32x32x16_bf16 v[72:87], v[108:111], v[100:103], v[72:87]
    s_waitcnt vmcnt(24)
    s_barrier
    s_mov_b32 s37, 3328
    s_mov_b32 s38, 2129920
    s_add_u32 m0, s35, 32768
    s_nop 0
    buffer_load_dwordx4 v28, s[4:7], s37 offen lds
    s_add_u32 m0, s35, 33792
    s_nop 0
    buffer_load_dwordx4 v29, s[4:7], s37 offen lds
    s_add_u32 m0, s35, 34816
    s_nop 0
    buffer_load_dwordx4 v30, s[4:7], s37 offen lds
    s_add_u32 m0, s35, 35840
    s_nop 0
    buffer_load_dwordx4 v31, s[4:7], s37 offen lds
    s_add_u32 m0, s36, 114688
    s_nop 0
    buffer_load_dwordx4 v32, s[8:11], s38 offen lds
    s_add_u32 m0, s36, 115712
    s_nop 0
    buffer_load_dwordx4 v33, s[8:11], s38 offen lds
    ds_read_b128 v[88:91], v34 offset:49152
    ds_read_b128 v[92:95], v38 offset:49152
    ds_read_b64_tr_b16 v[104:105], v50 offset:24576
    ds_read_b64_tr_b16 v[106:107], v50 offset:25088
    ds_read_b128 v[96:99], v35 offset:49152
    ds_read_b128 v[100:103], v39 offset:49152
    ds_read_b64_tr_b16 v[108:109], v50 offset:26624
    ds_read_b64_tr_b16 v[110:111], v50 offset:27136
    s_waitcnt lgkmcnt(4)
    v_mfma_f32_32x32x16_bf16 v[56:71], v[104:107], v[88:91], v[56:71]
    v_mfma_f32_32x32x16_bf16 v[72:87], v[104:107], v[92:95], v[72:87]
    ds_read_b128 v[88:91], v36 offset:49152
    ds_read_b128 v[92:95], v40 offset:49152
    ds_read_b64_tr_b16 v[104:105], v50 offset:28672
    ds_read_b64_tr_b16 v[106:107], v50 offset:29184
    s_waitcnt lgkmcnt(4)
    v_mfma_f32_32x32x16_bf16 v[56:71], v[108:111], v[96:99], v[56:71]
    v_mfma_f32_32x32x16_bf16 v[72:87], v[108:111], v[100:103], v[72:87]
    ds_read_b128 v[96:99], v37 offset:49152
    ds_read_b128 v[100:103], v41 offset:49152
    ds_read_b64_tr_b16 v[108:109], v50 offset:30720
    ds_read_b64_tr_b16 v[110:111], v50 offset:31232
    s_waitcnt lgkmcnt(4)
    v_mfma_f32_32x32x16_bf16 v[56:71], v[104:107], v[88:91], v[56:71]
    v_mfma_f32_32x32x16_bf16 v[72:87], v[104:107], v[92:95], v[72:87]
    s_waitcnt lgkmcnt(0)
    v_mfma_f32_32x32x16_bf16 v[56:71], v[108:111], v[96:99], v[56:71]
    v_mfma_f32_32x32x16_bf16 v[72:87], v[108:111], v[100:103], v[72:87]
    s_waitcnt vmcnt(24)
    s_barrier
    ds_read_b128 v[88:91], v42 offset:0
    ds_read_b128 v[92:95], v46 offset:0
    ds_read_b64_tr_b16 v[104:105], v50 offset:32768
    ds_read_b64_tr_b16 v[106:107], v50 offset:33280
    ds_read_b128 v[96:99], v43 offset:0
    ds_read_b128 v[100:103], v47 offset:0
    ds_read_b64_tr_b16 v[108:109], v50 offset:34816
    ds_read_b64_tr_b16 v[110:111], v50 offset:35328
    s_waitcnt lgkmcnt(4)
    v_mfma_f32_32x32x16_bf16 v[56:71], v[104:107], v[88:91], v[56:71]
    v_mfma_f32_32x32x16_bf16 v[72:87], v[104:107], v[92:95], v[72:87]
    ds_read_b128 v[88:91], v44 offset:0
    ds_read_b128 v[92:95], v48 offset:0
    ds_read_b64_tr_b16 v[104:105], v50 offset:36864
    ds_read_b64_tr_b16 v[106:107], v50 offset:37376
    s_waitcnt lgkmcnt(4)
    v_mfma_f32_32x32x16_bf16 v[56:71], v[108:111], v[96:99], v[56:71]
    v_mfma_f32_32x32x16_bf16 v[72:87], v[108:111], v[100:103], v[72:87]
    ds_read_b128 v[96:99], v45 offset:0
    ds_read_b128 v[100:103], v49 offset:0
    ds_read_b64_tr_b16 v[108:109], v50 offset:38912
    ds_read_b64_tr_b16 v[110:111], v50 offset:39424
    s_waitcnt lgkmcnt(4)
    v_mfma_f32_32x32x16_bf16 v[56:71], v[104:107], v[88:91], v[56:71]
    v_mfma_f32_32x32x16_bf16 v[72:87], v[104:107], v[92:95], v[72:87]
    s_waitcnt lgkmcnt(0)
    v_mfma_f32_32x32x16_bf16 v[56:71], v[108:111], v[96:99], v[56:71]
    v_mfma_f32_32x32x16_bf16 v[72:87], v[108:111], v[100:103], v[72:87]
    s_waitcnt vmcnt(18)
    s_barrier
    ds_read_b128 v[88:91], v42 offset:16384
    ds_read_b128 v[92:95], v46 offset:16384
    ds_read_b64_tr_b16 v[104:105], v50 offset:40960
    ds_read_b64_tr_b16 v[106:107], v50 offset:41472
    ds_read_b128 v[96:99], v43 offset:16384
    ds_read_b128 v[100:103], v47 offset:16384
    ds_read_b64_tr_b16 v[108:109], v50 offset:43008
    ds_read_b64_tr_b16 v[110:111], v50 offset:43520
    s_waitcnt lgkmcnt(4)
    v_mfma_f32_32x32x16_bf16 v[56:71], v[104:107], v[88:91], v[56:71]
    v_mfma_f32_32x32x16_bf16 v[72:87], v[104:107], v[92:95], v[72:87]
    ds_read_b128 v[88:91], v44 offset:16384
    ds_read_b128 v[92:95], v48 offset:16384
    ds_read_b64_tr_b16 v[104:105], v50 offset:45056
    ds_read_b64_tr_b16 v[106:107], v50 offset:45568
    s_waitcnt lgkmcnt(4)
    v_mfma_f32_32x32x16_bf16 v[56:71], v[108:111], v[96:99], v[56:71]
    v_mfma_f32_32x32x16_bf16 v[72:87], v[108:111], v[100:103], v[72:87]
    ds_read_b128 v[96:99], v45 offset:16384
    ds_read_b128 v[100:103], v49 offset:16384
    ds_read_b64_tr_b16 v[108:109], v50 offset:47104
    ds_read_b64_tr_b16 v[110:111], v50 offset:47616
    s_waitcnt lgkmcnt(4)
    v_mfma_f32_32x32x16_bf16 v[56:71], v[104:107], v[88:91], v[56:71]
    v_mfma_f32_32x32x16_bf16 v[72:87], v[104:107], v[92:95], v[72:87]
    s_waitcnt lgkmcnt(0)
    v_mfma_f32_32x32x16_bf16 v[56:71], v[108:111], v[96:99], v[56:71]
    v_mfma_f32_32x32x16_bf16 v[72:87], v[108:111], v[100:103], v[72:87]
    s_waitcnt vmcnt(12)
    s_barrier
    ds_read_b128 v[88:91], v34 offset:0
    ds_read_b128 v[92:95], v38 offset:0
    ds_read_b64_tr_b16 v[104:105], v50 offset:0
    ds_read_b64_tr_b16 v[106:107], v50 offset:512
    ds_read_b128 v[96:99], v35 offset:0
    ds_read_b128 v[100:103], v39 offset:0
    ds_read_b64_tr_b16 v[108:109], v50 offset:2048
    ds_read_b64_tr_b16 v[110:111], v50 offset:2560
    s_waitcnt lgkmcnt(4)
    v_mfma_f32_32x32x16_bf16 v[56:71], v[104:107], v[88:91], v[56:71]
    v_mfma_f32_32x32x16_bf16 v[72:87], v[104:107], v[92:95], v[72:87]
    ds_read_b128 v[88:91], v36 offset:0
    ds_read_b128 v[92:95], v40 offset:0
    ds_read_b64_tr_b16 v[104:105], v50 offset:4096
    ds_read_b64_tr_b16 v[106:107], v50 offset:4608
    s_waitcnt lgkmcnt(4)
    v_mfma_f32_32x32x16_bf16 v[56:71], v[108:111], v[96:99], v[56:71]
    v_mfma_f32_32x32x16_bf16 v[72:87], v[108:111], v[100:103], v[72:87]
    ds_read_b128 v[96:99], v37 offset:0
    ds_read_b128 v[100:103], v41 offset:0
    ds_read_b64_tr_b16 v[108:109], v50 offset:6144
    ds_read_b64_tr_b16 v[110:111], v50 offset:6656
    s_waitcnt lgkmcnt(4)
    v_mfma_f32_32x32x16_bf16 v[56:71], v[104:107], v[88:91], v[56:71]
    v_mfma_f32_32x32x16_bf16 v[72:87], v[104:107], v[92:95], v[72:87]
    s_waitcnt lgkmcnt(0)
    v_mfma_f32_32x32x16_bf16 v[56:71], v[108:111], v[96:99], v[56:71]
    v_mfma_f32_32x32x16_bf16 v[72:87], v[108:111], v[100:103], v[72:87]
    s_waitcnt vmcnt(6)
    s_barrier
    ds_read_b128 v[88:91], v34 offset:16384
    ds_read_b128 v[92:95], v38 offset:16384
    ds_read_b64_tr_b16 v[104:105], v50 offset:8192
    ds_read_b64_tr_b16 v[106:107], v50 offset:8704
    ds_read_b128 v[96:99], v35 offset:16384
    ds_read_b128 v[100:103], v39 offset:16384
    ds_read_b64_tr_b16 v[108:109], v50 offset:10240
    ds_read_b64_tr_b16 v[110:111], v50 offset:10752
    s_waitcnt lgkmcnt(4)
    v_mfma_f32_32x32x16_bf16 v[56:71], v[104:107], v[88:91], v[56:71]
    v_mfma_f32_32x32x16_bf16 v[72:87], v[104:107], v[92:95], v[72:87]
    ds_read_b128 v[88:91], v36 offset:16384
    ds_read_b128 v[92:95], v40 offset:16384
    ds_read_b64_tr_b16 v[104:105], v50 offset:12288
    ds_read_b64_tr_b16 v[106:107], v50 offset:12800
    s_waitcnt lgkmcnt(4)
    v_mfma_f32_32x32x16_bf16 v[56:71], v[108:111], v[96:99], v[56:71]
    v_mfma_f32_32x32x16_bf16 v[72:87], v[108:111], v[100:103], v[72:87]
    ds_read_b128 v[96:99], v37 offset:16384
    ds_read_b128 v[100:103], v41 offset:16384
    ds_read_b64_tr_b16 v[108:109], v50 offset:14336
    ds_read_b64_tr_b16 v[110:111], v50 offset:14848
    s_waitcnt lgkmcnt(4)
    v_mfma_f32_32x32x16_bf16 v[56:71], v[104:107], v[88:91], v[56:71]
    v_mfma_f32_32x32x16_bf16 v[72:87], v[104:107], v[92:95], v[72:87]
    s_waitcnt lgkmcnt(0)
    v_mfma_f32_32x32x16_bf16 v[56:71], v[108:111], v[96:99], v[56:71]
    v_mfma_f32_32x32x16_bf16 v[72:87], v[108:111], v[100:103], v[72:87]
    s_waitcnt vmcnt(0)
    s_barrier
    ds_read_b128 v[88:91], v34 offset:32768
    ds_read_b128 v[92:95], v38 offset:32768
    ds_read_b64_tr_b16 v[104:105], v50 offset:16384
    ds_read_b64_tr_b16 v[106:107], v50 offset:16896
    ds_read_b128 v[96:99], v35 offset:32768
    ds_read_b128 v[100:103], v39 offset:32768
    ds_read_b64_tr_b16 v[108:109], v50 offset:18432
    ds_read_b64_tr_b16 v[110:111], v50 offset:18944
    s_waitcnt lgkmcnt(4)
    v_mfma_f32_32x32x16_bf16 v[56:71], v[104:107], v[88:91], v[56:71]
    v_mfma_f32_32x32x16_bf16 v[72:87], v[104:107], v[92:95], v[72:87]
    ds_read_b128 v[88:91], v36 offset:32768
    ds_read_b128 v[92:95], v40 offset:32768
    ds_read_b64_tr_b16 v[104:105], v50 offset:20480
    ds_read_b64_tr_b16 v[106:107], v50 offset:20992
    s_waitcnt lgkmcnt(4)
    v_mfma_f32_32x32x16_bf16 v[56:71], v[108:111], v[96:99], v[56:71]
    v_mfma_f32_32x32x16_bf16 v[72:87], v[108:111], v[100:103], v[72:87]
    ds_read_b128 v[96:99], v37 offset:32768
    ds_read_b128 v[100:103], v41 offset:32768
    ds_read_b64_tr_b16 v[108:109], v50 offset:22528
    ds_read_b64_tr_b16 v[110:111], v50 offset:23040
    s_waitcnt lgkmcnt(4)
    v_mfma_f32_32x32x16_bf16 v[56:71], v[104:107], v[88:91], v[56:71]
    v_mfma_f32_32x32x16_bf16 v[72:87], v[104:107], v[92:95], v[72:87]
    s_waitcnt lgkmcnt(0)
    v_mfma_f32_32x32x16_bf16 v[56:71], v[108:111], v[96:99], v[56:71]
    v_mfma_f32_32x32x16_bf16 v[72:87], v[108:111], v[100:103], v[72:87]
    s_nop 15
    s_nop 3
    s_barrier
    ds_write_b128 v20, v[4:7]
    ds_write_b128 v21, v[8:11]
    ds_write_b128 v22, v[12:15]
    ds_write_b128 v23, v[16:19]
    s_waitcnt lgkmcnt(0)
    s_barrier
    v_lshrrev_b32 v25, 5, v24
    v_lshlrev_b32 v25, 2, v25
    v_lshrrev_b32 v26, 2, v24
    v_and_b32 v26, 3, v26
    v_add_u32 v25, v25, v26
    s_lshl_b32 s26, s32, 5
    v_add_u32 v25, s26, v25
    s_mov_b32 s27, 272
    v_mul_lo_u32 v112, v25, s27
    v_lshrrev_b32 v25, 4, v24
    v_and_b32 v25, 1, v25
    v_lshlrev_b32 v25, 5, v25
    v_and_b32 v26, 3, v24
    v_lshl_add_u32 v25, v26, 3, v25
    s_lshl_b32 s26, s31, 7
    v_add3_u32 v112, v112, v25, s26
    v_and_b32 v25, 31, v24
    s_lshl_b32 s26, s31, 6
    s_add_u32 s26, s26, s28
    v_add_u32 v25, s26, v25
    s_mov_b32 s26, 0xc00000
    v_lshlrev_b32 v26, 2, v25
    buffer_load_dword v114, v26, s[16:19], s26 offen offset:0
    v_lshlrev_b32 v26, 2, v25
    buffer_load_dword v115, v26, s[16:19], s26 offen offset:128
    s_mul_i32 s27, s30, 5120
    s_add_u32 s27, s27, 20480
    v_and_b32 v25, 31, v24
    v_mul_u32_u24 v25, 80, v25
    v_lshrrev_b32 v26, 5, v24
    v_lshlrev_b32 v26, 3, v26
    v_add3_u32 v116, v25, v26, s27
    v_lshrrev_b32 v25, 2, v24
    v_mul_u32_u24 v27, 80, v25
    v_and_b32 v26, 3, v24
    v_lshlrev_b32 v26, 4, v26
    v_add3_u32 v117, v27, v26, s27
    s_lshl_b32 s26, s31, 6
    s_add_u32 s26, s26, s28
    v_add_u32 v25, s26, v25
    v_mul_u32_u24 v113, 1280, v25
    s_lshl_b32 s27, s32, 6
    s_lshl_b32 s26, s29, 1
    s_add_u32 s26, s26, s27
    v_add3_u32 v113, v113, v26, s26
    s_waitcnt vmcnt(0)
    ds_read_b64_tr_b16 v[120:121], v112 offset:0
    ds_read_b64_tr_b16 v[122:123], v112 offset:2176
    ds_read_b64_tr_b16 v[124:125], v112 offset:4352
    ds_read_b64_tr_b16 v[126:127], v112 offset:6528
    v_sub_f32 v134, 1.0, v114
    v_cvt_pk_bf16_f32 v134, v134, v134
    v_lshlrev_b32 v134, 16, v134
    s_waitcnt lgkmcnt(0)
    v_cvt_pk_bf16_f32 v128, v56, v57
    v_cvt_pk_bf16_f32 v129, v58, v59
    v_lshlrev_b32 v56, 16, v128
    v_and_b32 v57, 0xffff0000, v128
    v_lshlrev_b32 v58, 16, v129
    v_and_b32 v59, 0xffff0000, v129
    v_lshlrev_b32 v130, 16, v120
    v_and_b32 v131, 0xffff0000, v120
    v_lshlrev_b32 v132, 16, v121
    v_and_b32 v133, 0xffff0000, v121
    v_mul_f32 v130, v114, v130
    v_mul_f32 v56, v134, v56
    v_mul_f32 v131, v114, v131
    v_mul_f32 v57, v134, v57
    v_mul_f32 v132, v114, v132
    v_mul_f32 v58, v134, v58
    v_mul_f32 v133, v114, v133
    v_mul_f32 v59, v134, v59
    v_cvt_pk_bf16_f32 v128, v130, v131
    v_cvt_pk_bf16_f32 v129, v132, v133
    v_lshlrev_b32 v130, 16, v128
    v_and_b32 v131, 0xffff0000, v128
    v_lshlrev_b32 v132, 16, v129
    v_and_b32 v133, 0xffff0000, v129
    v_cvt_pk_bf16_f32 v128, v56, v57
    v_cvt_pk_bf16_f32 v129, v58, v59
    v_lshlrev_b32 v56, 16, v128
    v_and_b32 v57, 0xffff0000, v128
    v_lshlrev_b32 v58, 16, v129
    v_and_b32 v59, 0xffff0000, v129
    v_add_f32 v130, v130, v56
    v_add_f32 v131, v131, v57
    v_add_f32 v132, v132, v58
    v_add_f32 v133, v133, v59
    v_cvt_pk_bf16_f32 v128, v130, v131
    v_cvt_pk_bf16_f32 v129, v132, v133
    ds_write_b64 v116, v[128:129] offset:0
    v_cvt_pk_bf16_f32 v128, v60, v61
    v_cvt_pk_bf16_f32 v129, v62, v63
    v_lshlrev_b32 v60, 16, v128
    v_and_b32 v61, 0xffff0000, v128
    v_lshlrev_b32 v62, 16, v129
    v_and_b32 v63, 0xffff0000, v129
    v_lshlrev_b32 v130, 16, v122
    v_and_b32 v131, 0xffff0000, v122
    v_lshlrev_b32 v132, 16, v123
    v_and_b32 v133, 0xffff0000, v123
    v_mul_f32 v130, v114, v130
    v_mul_f32 v60, v134, v60
    v_mul_f32 v131, v114, v131
    v_mul_f32 v61, v134, v61
    v_mul_f32 v132, v114, v132
    v_mul_f32 v62, v134, v62
    v_mul_f32 v133, v114, v133
    v_mul_f32 v63, v134, v63
    v_cvt_pk_bf16_f32 v128, v130, v131
    v_cvt_pk_bf16_f32 v129, v132, v133
    v_lshlrev_b32 v130, 16, v128
    v_and_b32 v131, 0xffff0000, v128
    v_lshlrev_b32 v132, 16, v129
    v_and_b32 v133, 0xffff0000, v129
    v_cvt_pk_bf16_f32 v128, v60, v61
    v_cvt_pk_bf16_f32 v129, v62, v63
    v_lshlrev_b32 v60, 16, v128
    v_and_b32 v61, 0xffff0000, v128
    v_lshlrev_b32 v62, 16, v129
    v_and_b32 v63, 0xffff0000, v129
    v_add_f32 v130, v130, v60
    v_add_f32 v131, v131, v61
    v_add_f32 v132, v132, v62
    v_add_f32 v133, v133, v63
    v_cvt_pk_bf16_f32 v128, v130, v131
    v_cvt_pk_bf16_f32 v129, v132, v133
    ds_write_b64 v116, v[128:129] offset:16
    v_cvt_pk_bf16_f32 v128, v64, v65
    v_cvt_pk_bf16_f32 v129, v66, v67
    v_lshlrev_b32 v64, 16, v128
    v_and_b32 v65, 0xffff0000, v128
    v_lshlrev_b32 v66, 16, v129
    v_and_b32 v67, 0xffff0000, v129
    v_lshlrev_b32 v130, 16, v124
    v_and_b32 v131, 0xffff0000, v124
    v_lshlrev_b32 v132, 16, v125
    v_and_b32 v133, 0xffff0000, v125
    v_mul_f32 v130, v114, v130
    v_mul_f32 v64, v134, v64
    v_mul_f32 v131, v114, v131
    v_mul_f32 v65, v134, v65
    v_mul_f32 v132, v114, v132
    v_mul_f32 v66, v134, v66
    v_mul_f32 v133, v114, v133
    v_mul_f32 v67, v134, v67
    v_cvt_pk_bf16_f32 v128, v130, v131
    v_cvt_pk_bf16_f32 v129, v132, v133
    v_lshlrev_b32 v130, 16, v128
    v_and_b32 v131, 0xffff0000, v128
    v_lshlrev_b32 v132, 16, v129
    v_and_b32 v133, 0xffff0000, v129
    v_cvt_pk_bf16_f32 v128, v64, v65
    v_cvt_pk_bf16_f32 v129, v66, v67
    v_lshlrev_b32 v64, 16, v128
    v_and_b32 v65, 0xffff0000, v128
    v_lshlrev_b32 v66, 16, v129
    v_and_b32 v67, 0xffff0000, v129
    v_add_f32 v130, v130, v64
    v_add_f32 v131, v131, v65
    v_add_f32 v132, v132, v66
    v_add_f32 v133, v133, v67
    v_cvt_pk_bf16_f32 v128, v130, v131
    v_cvt_pk_bf16_f32 v129, v132, v133
    ds_write_b64 v116, v[128:129] offset:32
    v_cvt_pk_bf16_f32 v128, v68, v69
    v_cvt_pk_bf16_f32 v129, v70, v71
    v_lshlrev_b32 v68, 16, v128
    v_and_b32 v69, 0xffff0000, v128
    v_lshlrev_b32 v70, 16, v129
    v_and_b32 v71, 0xffff0000, v129
    v_lshlrev_b32 v130, 16, v126
    v_and_b32 v131, 0xffff0000, v126
    v_lshlrev_b32 v132, 16, v127
    v_and_b32 v133, 0xffff0000, v127
    v_mul_f32 v130, v114, v130
    v_mul_f32 v68, v134, v68
    v_mul_f32 v131, v114, v131
    v_mul_f32 v69, v134, v69
    v_mul_f32 v132, v114, v132
    v_mul_f32 v70, v134, v70
    v_mul_f32 v133, v114, v133
    v_mul_f32 v71, v134, v71
    v_cvt_pk_bf16_f32 v128, v130, v131
    v_cvt_pk_bf16_f32 v129, v132, v133
    v_lshlrev_b32 v130, 16, v128
    v_and_b32 v131, 0xffff0000, v128
    v_lshlrev_b32 v132, 16, v129
    v_and_b32 v133, 0xffff0000, v129
    v_cvt_pk_bf16_f32 v128, v68, v69
    v_cvt_pk_bf16_f32 v129, v70, v71
    v_lshlrev_b32 v68, 16, v128
    v_and_b32 v69, 0xffff0000, v128
    v_lshlrev_b32 v70, 16, v129
    v_and_b32 v71, 0xffff0000, v129
    v_add_f32 v130, v130, v68
    v_add_f32 v131, v131, v69
    v_add_f32 v132, v132, v70
    v_add_f32 v133, v133, v71
    v_cvt_pk_bf16_f32 v128, v130, v131
    v_cvt_pk_bf16_f32 v129, v132, v133
    ds_write_b64 v116, v[128:129] offset:48
    ds_read_b64_tr_b16 v[120:121], v112 offset:64
    ds_read_b64_tr_b16 v[122:123], v112 offset:2240
    ds_read_b64_tr_b16 v[124:125], v112 offset:4416
    ds_read_b64_tr_b16 v[126:127], v112 offset:6592
    v_sub_f32 v134, 1.0, v115
    v_cvt_pk_bf16_f32 v134, v134, v134
    v_lshlrev_b32 v134, 16, v134
    s_waitcnt lgkmcnt(0)
    v_cvt_pk_bf16_f32 v128, v72, v73
    v_cvt_pk_bf16_f32 v129, v74, v75
    v_lshlrev_b32 v72, 16, v128
    v_and_b32 v73, 0xffff0000, v128
    v_lshlrev_b32 v74, 16, v129
    v_and_b32 v75, 0xffff0000, v129
    v_lshlrev_b32 v130, 16, v120
    v_and_b32 v131, 0xffff0000, v120
    v_lshlrev_b32 v132, 16, v121
    v_and_b32 v133, 0xffff0000, v121
    v_mul_f32 v130, v115, v130
    v_mul_f32 v72, v134, v72
    v_mul_f32 v131, v115, v131
    v_mul_f32 v73, v134, v73
    v_mul_f32 v132, v115, v132
    v_mul_f32 v74, v134, v74
    v_mul_f32 v133, v115, v133
    v_mul_f32 v75, v134, v75
    v_cvt_pk_bf16_f32 v128, v130, v131
    v_cvt_pk_bf16_f32 v129, v132, v133
    v_lshlrev_b32 v130, 16, v128
    v_and_b32 v131, 0xffff0000, v128
    v_lshlrev_b32 v132, 16, v129
    v_and_b32 v133, 0xffff0000, v129
    v_cvt_pk_bf16_f32 v128, v72, v73
    v_cvt_pk_bf16_f32 v129, v74, v75
    v_lshlrev_b32 v72, 16, v128
    v_and_b32 v73, 0xffff0000, v128
    v_lshlrev_b32 v74, 16, v129
    v_and_b32 v75, 0xffff0000, v129
    v_add_f32 v130, v130, v72
    v_add_f32 v131, v131, v73
    v_add_f32 v132, v132, v74
    v_add_f32 v133, v133, v75
    v_cvt_pk_bf16_f32 v128, v130, v131
    v_cvt_pk_bf16_f32 v129, v132, v133
    ds_write_b64 v116, v[128:129] offset:2560
    v_cvt_pk_bf16_f32 v128, v76, v77
    v_cvt_pk_bf16_f32 v129, v78, v79
    v_lshlrev_b32 v76, 16, v128
    v_and_b32 v77, 0xffff0000, v128
    v_lshlrev_b32 v78, 16, v129
    v_and_b32 v79, 0xffff0000, v129
    v_lshlrev_b32 v130, 16, v122
    v_and_b32 v131, 0xffff0000, v122
    v_lshlrev_b32 v132, 16, v123
    v_and_b32 v133, 0xffff0000, v123
    v_mul_f32 v130, v115, v130
    v_mul_f32 v76, v134, v76
    v_mul_f32 v131, v115, v131
    v_mul_f32 v77, v134, v77
    v_mul_f32 v132, v115, v132
    v_mul_f32 v78, v134, v78
    v_mul_f32 v133, v115, v133
    v_mul_f32 v79, v134, v79
    v_cvt_pk_bf16_f32 v128, v130, v131
    v_cvt_pk_bf16_f32 v129, v132, v133
    v_lshlrev_b32 v130, 16, v128
    v_and_b32 v131, 0xffff0000, v128
    v_lshlrev_b32 v132, 16, v129
    v_and_b32 v133, 0xffff0000, v129
    v_cvt_pk_bf16_f32 v128, v76, v77
    v_cvt_pk_bf16_f32 v129, v78, v79
    v_lshlrev_b32 v76, 16, v128
    v_and_b32 v77, 0xffff0000, v128
    v_lshlrev_b32 v78, 16, v129
    v_and_b32 v79, 0xffff0000, v129
    v_add_f32 v130, v130, v76
    v_add_f32 v131, v131, v77
    v_add_f32 v132, v132, v78
    v_add_f32 v133, v133, v79
    v_cvt_pk_bf16_f32 v128, v130, v131
    v_cvt_pk_bf16_f32 v129, v132, v133
    ds_write_b64 v116, v[128:129] offset:2576
    v_cvt_pk_bf16_f32 v128, v80, v81
    v_cvt_pk_bf16_f32 v129, v82, v83
    v_lshlrev_b32 v80, 16, v128
    v_and_b32 v81, 0xffff0000, v128
    v_lshlrev_b32 v82, 16, v129
    v_and_b32 v83, 0xffff0000, v129
    v_lshlrev_b32 v130, 16, v124
    v_and_b32 v131, 0xffff0000, v124
    v_lshlrev_b32 v132, 16, v125
    v_and_b32 v133, 0xffff0000, v125
    v_mul_f32 v130, v115, v130
    v_mul_f32 v80, v134, v80
    v_mul_f32 v131, v115, v131
    v_mul_f32 v81, v134, v81
    v_mul_f32 v132, v115, v132
    v_mul_f32 v82, v134, v82
    v_mul_f32 v133, v115, v133
    v_mul_f32 v83, v134, v83
    v_cvt_pk_bf16_f32 v128, v130, v131
    v_cvt_pk_bf16_f32 v129, v132, v133
    v_lshlrev_b32 v130, 16, v128
    v_and_b32 v131, 0xffff0000, v128
    v_lshlrev_b32 v132, 16, v129
    v_and_b32 v133, 0xffff0000, v129
    v_cvt_pk_bf16_f32 v128, v80, v81
    v_cvt_pk_bf16_f32 v129, v82, v83
    v_lshlrev_b32 v80, 16, v128
    v_and_b32 v81, 0xffff0000, v128
    v_lshlrev_b32 v82, 16, v129
    v_and_b32 v83, 0xffff0000, v129
    v_add_f32 v130, v130, v80
    v_add_f32 v131, v131, v81
    v_add_f32 v132, v132, v82
    v_add_f32 v133, v133, v83
    v_cvt_pk_bf16_f32 v128, v130, v131
    v_cvt_pk_bf16_f32 v129, v132, v133
    ds_write_b64 v116, v[128:129] offset:2592
    v_cvt_pk_bf16_f32 v128, v84, v85
    v_cvt_pk_bf16_f32 v129, v86, v87
    v_lshlrev_b32 v84, 16, v128
    v_and_b32 v85, 0xffff0000, v128
    v_lshlrev_b32 v86, 16, v129
    v_and_b32 v87, 0xffff0000, v129
    v_lshlrev_b32 v130, 16, v126
    v_and_b32 v131, 0xffff0000, v126
    v_lshlrev_b32 v132, 16, v127
    v_and_b32 v133, 0xffff0000, v127
    v_mul_f32 v130, v115, v130
    v_mul_f32 v84, v134, v84
    v_mul_f32 v131, v115, v131
    v_mul_f32 v85, v134, v85
    v_mul_f32 v132, v115, v132
    v_mul_f32 v86, v134, v86
    v_mul_f32 v133, v115, v133
    v_mul_f32 v87, v134, v87
    v_cvt_pk_bf16_f32 v128, v130, v131
    v_cvt_pk_bf16_f32 v129, v132, v133
    v_lshlrev_b32 v130, 16, v128
    v_and_b32 v131, 0xffff0000, v128
    v_lshlrev_b32 v132, 16, v129
    v_and_b32 v133, 0xffff0000, v129
    v_cvt_pk_bf16_f32 v128, v84, v85
    v_cvt_pk_bf16_f32 v129, v86, v87
    v_lshlrev_b32 v84, 16, v128
    v_and_b32 v85, 0xffff0000, v128
    v_lshlrev_b32 v86, 16, v129
    v_and_b32 v87, 0xffff0000, v129
    v_add_f32 v130, v130, v84
    v_add_f32 v131, v131, v85
    v_add_f32 v132, v132, v86
    v_add_f32 v133, v133, v87
    v_cvt_pk_bf16_f32 v128, v130, v131
    v_cvt_pk_bf16_f32 v129, v132, v133
    ds_write_b64 v116, v[128:129] offset:2608
    s_waitcnt lgkmcnt(0)
    ds_read_b128 v[56:59], v117 offset:0
    ds_read_b128 v[60:63], v117 offset:1280
    ds_read_b128 v[64:67], v117 offset:2560
    ds_read_b128 v[68:71], v117 offset:3840
    s_mov_b32 s27, 0
    s_waitcnt lgkmcnt(3)
    buffer_store_dwordx4 v[56:59], v113, s[12:15], s27 offen
    s_add_u32 s27, s27, 20480
    s_waitcnt lgkmcnt(2)
    buffer_store_dwordx4 v[60:63], v113, s[12:15], s27 offen
    s_add_u32 s27, s27, 20480
    s_waitcnt lgkmcnt(1)
    buffer_store_dwordx4 v[64:67], v113, s[12:15], s27 offen
    s_add_u32 s27, s27, 20480
    s_waitcnt lgkmcnt(0)
    buffer_store_dwordx4 v[68:71], v113, s[12:15], s27 offen
L_end_gemm2_kernel:
    s_endpgm
.section .rodata,"a"
.p2align 6
.amdhsa_kernel k1_kernel
  .amdhsa_next_free_vgpr 126
  .amdhsa_next_free_sgpr 102
  .amdhsa_accum_offset 128
  .amdhsa_group_segment_fixed_size 0
  .amdhsa_kernarg_size 112
  .amdhsa_user_sgpr_count 2
  .amdhsa_user_sgpr_kernarg_segment_ptr 1
  .amdhsa_system_sgpr_workgroup_id_x 1
.end_amdhsa_kernel
.p2align 6
.amdhsa_kernel gemm2_kernel
  .amdhsa_next_free_vgpr 135
  .amdhsa_next_free_sgpr 102
  .amdhsa_accum_offset 136
  .amdhsa_group_segment_fixed_size 0
  .amdhsa_kernarg_size 112
  .amdhsa_user_sgpr_count 2
  .amdhsa_user_sgpr_kernarg_segment_ptr 1
  .amdhsa_system_sgpr_workgroup_id_x 1
.end_amdhsa_kernel
```
